```python
import torch

def _softmax(x, axis=-1):
    return torch.softmax(x, dim=axis)

def _gelu(x):
    return torch.nn.functional.gelu(x, approximate='tanh')

def _silu(x):
    return torch.nn.functional.silu(x)

def _sigmoid(x):
    return torch.sigmoid(x)

def _layernorm(x, axis=-1, eps=1e-05):
    m = x.mean(dim=axis, keepdim=True)
    v = x.var(dim=axis, keepdim=True, unbiased=False)
    return (x - m) / torch.sqrt(v + eps)

def _scatter_add(tgt, idx, src, axis=0):
    return tgt.clone().index_add_(axis, idx, src)

def _segment_sum(src, seg, n):
    out = torch.zeros((n,) + src.shape[1:], dtype=src.dtype)
    return out.index_add_(0, seg, src)

def _pad(x, pw):
    flat = tuple((v for pair in reversed(pw) for v in pair))
    return torch.nn.functional.pad(x, flat)
kernel_name = 'adaLN_cond__sliding_block_cached__glu_gated_bilinear__prompt'

def setup_inputs():

    _w = lambda a: (lambda t: t.to(torch.bfloat16) if t.is_floating_point() else t)(torch.as_tensor(a))

    def _A_setup():
        B, Sq, D = (1, 2048, 512)
        Hq, Hkv, Sk, Dh = (32, 32, 2048, 128)
        assert Hq % Hkv == 0, (Hq, Hkv)
        return {'x': _w((lambda *s: torch.randn(*s, dtype=torch.bfloat16) * 0.05)(B, Sq, D)), 'k_cache': _w((lambda *s: torch.randn(*s, dtype=torch.bfloat16) * 1.6)(B, Hkv, Sk, Dh)), 'v_cache': _w((lambda *s: torch.randn(*s, dtype=torch.bfloat16) * 0.8)(B, Hkv, Sk, Dh)), 'wq': _w((lambda *s: torch.randn(*s, dtype=torch.bfloat16) * 1.6)(D, Hq * Dh) * D ** (-0.5)), 'wo': _w((lambda *s: torch.randn(*s, dtype=torch.bfloat16) * 0.8)(Hq * Dh, D) * (Hq * Dh) ** (-0.5))}
    _A_in = _A_setup()

    def _B_setup():
        B, S, D, F = (1, 2048, 512, 1376)
        return {'x': _w((lambda *s: torch.randn(*s, dtype=torch.bfloat16) * 0.05)(B, S, D)), 'w_gate': _w((lambda *s: torch.randn(*s, dtype=torch.bfloat16) * 0.4)(D, F) * D ** (-0.5)), 'w_up': _w((lambda *s: torch.randn(*s, dtype=torch.bfloat16) * 0.4)(D, F) * D ** (-0.5)), 'w_down': _w((lambda *s: torch.randn(*s, dtype=torch.bfloat16) * 0.4)(F, D) * F ** (-0.5))}
    _B_in = _B_setup()
    return {'A_x': _A_in['x'], 'A_k_cache': _A_in['k_cache'], 'A_v_cache': _A_in['v_cache'], 'A_wq': _A_in['wq'], 'A_wo': _A_in['wo'], 'B_x': _B_in['x'], 'B_w_gate': _B_in['w_gate'], 'B_w_up': _B_in['w_up'], 'B_w_down': _B_in['w_down'], 'c': _w((lambda *s: torch.randn(*s, dtype=torch.bfloat16) * 0.2)(1, 512) * 8.0), 'w_mod': _w((lambda *s: torch.randn(*s, dtype=torch.bfloat16) * 0.2)(512, 6 * 512) * 512 ** (-0.5) * 8.0)}

def reference(A_x, A_k_cache, A_v_cache, A_wq, A_wo, B_x, B_w_gate, B_w_up, B_w_down, c, w_mod):

    def _A_ref(x, k_cache, v_cache, wq, wo):
        B, Sq, D = x.shape
        Hq, Dh = (32, 128)
        Hkv, Sk = (k_cache.shape[1], k_cache.shape[2])
        W = min(4096, max(256, Sk // 4))
        rep = Hq // Hkv
        q = (lambda x, *d: x.permute(*d))((x @ wq).reshape(B, Sq, Hq, Dh), 0, 2, 1, 3)
        k = (lambda x, n, axis: torch.repeat_interleave(x, n, dim=axis))(k_cache[:, :, Sk - W:, :], rep, axis=1)
        v = (lambda x, n, axis: torch.repeat_interleave(x, n, dim=axis))(v_cache[:, :, Sk - W:, :], rep, axis=1)
        scores = torch.einsum('bhqd,bhkd->bhqk', q, k) * Dh ** (-0.5)
        p = _softmax(scores, axis=-1)
        o = torch.einsum('bhqk,bhkd->bhqd', p, v)
        return (lambda x, *d: x.permute(*d))(o, 0, 2, 1, 3).reshape(B, Sq, Hq * Dh) @ wo

    def _B_ref(x, w_gate, w_up, w_down):
        g = torch.einsum('bsd,df->bsf', x, w_gate)
        u = torch.einsum('bsd,df->bsf', x, w_up)
        h = g * u
        return torch.einsum('bsf,fd->bsd', h, w_down)
    x = A_x
    mod = (_silu(c) @ w_mod).reshape(c.shape[0], 6, 1, -1)
    sa, ca, ga, sb, cb, gb = (mod[:, 0].clone(), mod[:, 1].clone(), mod[:, 2].clone(), mod[:, 3].clone(), mod[:, 4].clone(), mod[:, 5].clone())
    h = _layernorm(x, axis=-1) * (1 + ca) + sa
    x = x + ga * _A_ref(h, A_k_cache, A_v_cache, A_wq, A_wo)
    h = _layernorm(x, axis=-1) * (1 + cb) + sb
    x = x + gb * _B_ref(h, B_w_gate, B_w_up, B_w_down)
    return x
```

```asm
; @launch grid=(256,1,1) block=(256,1,1) lds=163840
.amdgcn_target "amdgcn-amd-amdhsa--gfx950"
.text
.globl adaLN_cond__sliding_block_cached__glu_gated_bilinear__prompt_kernel
.p2align 8
.type adaLN_cond__sliding_block_cached__glu_gated_bilinear__prompt_kernel,@function
adaLN_cond__sliding_block_cached__glu_gated_bilinear__prompt_kernel:
  s_cmp_ge_u32 s2, 0x100
  s_cbranch_scc1 B_end
  v_mov_b32 v45, v0
  s_load_dwordx2 s[52:53], s[0:1], 0
  s_load_dwordx2 s[54:55], s[0:1], 104
  s_load_dwordx2 s[56:57], s[0:1], 96
  s_load_dwordx2 s[58:59], s[0:1], 80
  s_load_dwordx2 s[60:61], s[0:1], 72
  s_load_dwordx2 s[62:63], s[0:1], 24
  v_lshrrev_b32 v36, 6, v45
  v_and_b32 v1, 63, v45
  v_readfirstlane_b32 s28, v36
  s_and_b32 s29, s2, 7
  s_lshr_b32 s30, s2, 3
  s_nop 1
  s_cmp_lg_u32 s28, 1
  s_cbranch_scc1 M_no_codepf
  s_getpc_b64 s[92:93]
M_pc:
  s_sub_u32 s92, s92, M_pc-adaLN_cond__sliding_block_cached__glu_gated_bilinear__prompt_kernel
  s_subb_u32 s93, s93, 0
  s_mul_i32 s40, s30, 24
  v_min_u32 v36, 23, v1
  v_add_u32 v36, s40, v36
  v_lshlrev_b32 v36, 6, v36
  v_min_u32 v36, (B_end-adaLN_cond__sliding_block_cached__glu_gated_bilinear__prompt_kernel), v36
  global_load_dword a254, v36, s[92:93]
M_no_codepf:
  s_and_b32 s32, s30, 15
  s_lshl_b32 s31, s29, 2
  s_mov_b32 s46, 0xffff0000
  v_and_b32 v46, 15, v1
  v_lshrrev_b32 v47, 4, v1
  v_lshlrev_b32 v35, 4, v1
  v_mov_b32 v63, 0
  s_add_u32 s31, s31, s28
  s_mul_i32 s33, s28, 0x6000
  s_lshl_b32 s34, s28, 14
  s_add_u32 s34, s34, 0x18000
  s_lshl_b32 s39, s30, 6
  s_lshl_b32 s40, s28, 4
  s_add_u32 s39, s39, s40
  v_add_u32 v48, s39, v46
  v_lshlrev_b32 v48, 10, v48
  v_lshl_add_u32 v48, v47, 4, v48
  s_waitcnt lgkmcnt(0)
  s_mov_b32 s24, s52
  s_mov_b32 s25, s53
  s_mov_b32 s26, 0x200000
  s_mov_b32 s27, 0x20000
  s_mov_b32 s20, s54
  s_mov_b32 s21, s55
  s_mov_b32 s22, 0x2028000
  s_mov_b32 s23, 0x20000
  s_mov_b32 s96, s56
  s_mov_b32 s97, s57
  s_mov_b32 s98, 0x100
  s_mov_b32 s99, 0x20000
  s_mov_b32 s4, s62
  s_mov_b32 s5, s63
  s_mov_b32 s6, 0x400000
  s_mov_b32 s7, 0x20000
  s_load_dwordx2 s[76:77], s[0:1], 8
  s_load_dwordx2 s[78:79], s[0:1], 16
  s_load_dwordx2 s[80:81], s[0:1], 32
  s_load_dwordx2 s[82:83], s[0:1], 48
  s_load_dwordx2 s[84:85], s[0:1], 56
  s_load_dwordx2 s[86:87], s[0:1], 64
  s_load_dwordx2 s[88:89], s[0:1], 88
  s_mov_b32 s39, 0xf000
  buffer_load_dword a253, v63, s[20:23], s39 offen sc1
  s_mov_b32 s92, s58
  s_mov_b32 s93, s59
  s_mov_b32 s94, 0x300000
  s_mov_b32 s95, 0x20000
  s_mov_b32 s72, s60
  s_mov_b32 s73, s61
  s_mov_b32 s74, 0x400
  s_mov_b32 s75, 0x20000
  s_lshr_b32 s39, s30, 2
  s_lshl_b32 s39, s39, 3
  s_add_u32 s39, s39, s29
  s_lshl_b32 s39, s39, 2
  s_and_b32 s40, s30, 3
  s_add_u32 s39, s39, s40
  s_cmp_lt_u32 s2, 0x60
  s_cselect_b32 s71, s39, 0xff
  s_cmp_ge_u32 s71, 0x60
  s_cbranch_scc1 M_no_slab
  v_lshlrev_b32 v130, 2, v45
  buffer_load_dword a250, v130, s[72:75], 0 offen
  v_lshrrev_b32 v128, 2, v1
  s_mov_b32 s39, 0x1800
  v_mul_lo_u32 v128, v128, s39
  v_and_b32 v129, 3, v1
  v_lshl_add_u32 v132, v129, 4, v128
  v_add_u32 v133, 0x17c00, v132
  v_add_u32 v134, 0x2f800, v132
  v_add_u32 v135, 0x47400, v132
  s_mul_i32 s39, s28, 0xc0000
  s_lshl_b32 s40, s71, 6
  s_add_u32 s41, s39, s40
  s_add_u32 m0, s34, 0
  s_nop 0
  buffer_load_dwordx4 v132, s[92:95], s41 offen lds
  buffer_load_dwordx4 v133, s[92:95], s41 offen offset:1024 lds
  buffer_load_dwordx4 v134, s[92:95], s41 offen offset:2048 lds
  buffer_load_dwordx4 v135, s[92:95], s41 offen offset:3072 lds
  s_add_u32 m0, s34, 0x1000
  s_add_u32 s41, s41, 0x60000
  buffer_load_dwordx4 v132, s[92:95], s41 offen lds
  buffer_load_dwordx4 v133, s[92:95], s41 offen offset:1024 lds
  buffer_load_dwordx4 v134, s[92:95], s41 offen offset:2048 lds
  buffer_load_dwordx4 v135, s[92:95], s41 offen offset:3072 lds
M_no_slab:
  s_lshl_b32 s91, s32, 6
  s_cmp_lt_u32 s71, 0x60
  s_cbranch_scc1 M_x_later
  buffer_load_dwordx4 v[64:67], v48, s[24:27], s91 offen
  s_add_u32 s91, s91, 64
  s_and_b32 s91, s91, 0x3ff
  buffer_load_dwordx4 v[68:71], v48, s[24:27], s91 offen
  s_add_u32 s91, s91, 64
  s_and_b32 s91, s91, 0x3ff
  buffer_load_dwordx4 v[72:75], v48, s[24:27], s91 offen
  s_add_u32 s91, s91, 64
  s_and_b32 s91, s91, 0x3ff
  buffer_load_dwordx4 v[76:79], v48, s[24:27], s91 offen
  s_add_u32 s91, s91, 64
  s_and_b32 s91, s91, 0x3ff
  buffer_load_dwordx4 v[80:83], v48, s[24:27], s91 offen
  s_add_u32 s91, s91, 64
  s_and_b32 s91, s91, 0x3ff
  buffer_load_dwordx4 v[84:87], v48, s[24:27], s91 offen
  s_add_u32 s91, s91, 64
  s_and_b32 s91, s91, 0x3ff
  buffer_load_dwordx4 v[88:91], v48, s[24:27], s91 offen
  s_add_u32 s91, s91, 64
  s_and_b32 s91, s91, 0x3ff
  buffer_load_dwordx4 v[92:95], v48, s[24:27], s91 offen
  s_add_u32 s91, s91, 64
  s_and_b32 s91, s91, 0x3ff
  buffer_load_dwordx4 v[96:99], v48, s[24:27], s91 offen
  s_add_u32 s91, s91, 64
  s_and_b32 s91, s91, 0x3ff
  buffer_load_dwordx4 v[100:103], v48, s[24:27], s91 offen
  s_add_u32 s91, s91, 64
  s_and_b32 s91, s91, 0x3ff
  buffer_load_dwordx4 v[104:107], v48, s[24:27], s91 offen
  s_add_u32 s91, s91, 64
  s_and_b32 s91, s91, 0x3ff
  buffer_load_dwordx4 v[108:111], v48, s[24:27], s91 offen
  s_add_u32 s91, s91, 64
  s_and_b32 s91, s91, 0x3ff
  buffer_load_dwordx4 v[112:115], v48, s[24:27], s91 offen
  s_add_u32 s91, s91, 64
  s_and_b32 s91, s91, 0x3ff
  buffer_load_dwordx4 v[116:119], v48, s[24:27], s91 offen
  s_add_u32 s91, s91, 64
  s_and_b32 s91, s91, 0x3ff
  buffer_load_dwordx4 v[120:123], v48, s[24:27], s91 offen
  s_add_u32 s91, s91, 64
  s_and_b32 s91, s91, 0x3ff
  buffer_load_dwordx4 v[124:127], v48, s[24:27], s91 offen
M_x_later:
  s_waitcnt lgkmcnt(0)
  s_lshl_b32 s40, s31, 19
  s_add_u32 s40, s40, 0x60000
  s_add_u32 s8, s76, s40
  s_addc_u32 s9, s77, 0
  s_mov_b32 s10, 0x20000
  s_mov_b32 s11, 0x20000
  s_add_u32 s12, s78, s40
  s_addc_u32 s13, s79, 0
  s_mov_b32 s14, 0x20000
  s_mov_b32 s15, 0x20000
  s_lshl_b32 s40, s29, 19
  s_add_u32 s16, s80, s40
  s_addc_u32 s17, s81, 0
  s_mov_b32 s18, 0x80000
  s_mov_b32 s19, 0x20000
  s_lshl_b32 s36, s32, 13
  s_mov_b32 s37, s36
  v_lshrrev_b32 v36, 4, v1
  v_and_b32 v37, 15, v1
  s_mov_b32 s39, 0x100
  v_mul_lo_u32 v38, v36, s39
  v_add_u32 v39, 0, v36
  v_xor_b32 v39, v39, v37
  v_lshlrev_b32 v39, 4, v39
  v_add_u32 v40, v39, v38
  v_add_u32 v39, 4, v36
  v_xor_b32 v39, v39, v37
  v_lshlrev_b32 v39, 4, v39
  v_add_u32 v41, v39, v38
  v_add_u32 v39, 8, v36
  v_xor_b32 v39, v39, v37
  v_lshlrev_b32 v39, 4, v39
  v_add_u32 v42, v39, v38
  v_add_u32 v39, 12, v36
  v_xor_b32 v39, v39, v37
  v_lshlrev_b32 v39, 4, v39
  v_add_u32 v43, v39, v38
  v_mov_b32 v10, v40
  v_mov_b32 v11, v41
  v_mov_b32 v12, v42
  v_mov_b32 v13, v43
  v_add_u32 v14, 0x1000, v40
  v_add_u32 v15, 0x1000, v41
  v_add_u32 v16, 0x1000, v42
  v_add_u32 v17, 0x1000, v43
  v_lshrrev_b32 v36, 4, v1
  v_and_b32 v37, 15, v1
  s_mov_b32 s39, 0x100
  v_mul_lo_u32 v38, v36, s39
  v_add_u32 v39, 0, v36
  v_lshlrev_b32 v39, 1, v39
  v_xor_b32 v39, v39, v37
  v_lshlrev_b32 v39, 4, v39
  v_add_u32 v40, v39, v38
  v_add_u32 v39, 4, v36
  v_lshlrev_b32 v39, 1, v39
  v_xor_b32 v39, v39, v37
  v_lshlrev_b32 v39, 4, v39
  v_add_u32 v41, v39, v38
  v_mov_b32 v18, v40
  v_mov_b32 v19, v41
  v_add_u32 v20, 0x1000, v18
  v_add_u32 v21, 0x1000, v19
  v_lshrrev_b32 v36, 4, v1
  v_lshrrev_b32 v37, 2, v1
  v_and_b32 v37, 3, v37
  v_lshl_add_u32 v38, v36, 2, v37
  v_and_b32 v39, 7, v38
  v_lshlrev_b32 v39, 1, v39
  v_and_b32 v40, 3, v1
  v_lshrrev_b32 v41, 1, v40
  v_xor_b32 v39, v39, v41
  v_lshlrev_b32 v39, 4, v39
  v_and_b32 v40, 1, v40
  v_lshlrev_b32 v40, 3, v40
  v_lshlrev_b32 v38, 8, v38
  v_add3_u32 v44, v38, v39, v40
  v_lshrrev_b32 v36, 4, v1
  v_lshrrev_b32 v37, 2, v1
  v_and_b32 v37, 3, v37
  v_lshl_add_u32 v38, v36, 3, v37
  v_and_b32 v36, 1, v36
  v_lshl_add_u32 v39, v36, 2, v37
  v_lshlrev_b32 v39, 1, v39
  v_and_b32 v40, 3, v1
  v_xor_b32 v39, v39, v40
  v_lshlrev_b32 v39, 4, v39
  v_lshlrev_b32 v38, 8, v38
  v_add_u32 v22, v38, v39
  v_add_u32 v22, s33, v22
  v_xor_b32 v23, 8, v22
  v_xor_b32 v24, 64, v22
  v_xor_b32 v25, 0x48, v22
  v_xor_b32 v26, 0x80, v22
  v_xor_b32 v27, 0x88, v22
  v_xor_b32 v28, 0xc0, v22
  v_xor_b32 v29, 0xc8, v22
  v_xor_b32 v37, v47, v46
  v_lshlrev_b32 v37, 4, v37
  v_lshlrev_b32 v36, 8, v46
  v_add3_u32 v30, v36, v37, s33
  v_xor_b32 v31, 64, v30
  v_xor_b32 v32, 0x80, v30
  v_xor_b32 v33, 0xc0, v30
  v_add_u32 v34, 0x18000, v35
  v_mov_b32 v50, 0x3f803f80
  v_mov_b32 v54, 0
  v_mov_b32 v51, 0x3f803f80
  v_mov_b32 v55, 0
  v_mov_b32 v52, 0x3f803f80
  v_mov_b32 v56, 0
  v_mov_b32 v53, 0x3f803f80
  v_mov_b32 v57, 0
  v_accvgpr_write_b32 a144, v50
  v_accvgpr_write_b32 a145, v51
  v_accvgpr_write_b32 a146, v52
  v_accvgpr_write_b32 a147, v53
  v_mfma_f32_32x32x16_bf16 a[0:15], v[54:57], v[54:57], 0
  v_mfma_f32_32x32x16_bf16 a[16:31], v[54:57], v[54:57], 0
  v_mfma_f32_32x32x16_bf16 a[32:47], v[54:57], v[54:57], 0
  v_mfma_f32_32x32x16_bf16 a[48:63], v[54:57], v[54:57], 0
  v_mfma_f32_32x32x16_bf16 a[64:79], v[54:57], v[54:57], 0
  v_mfma_f32_32x32x16_bf16 a[80:95], v[54:57], v[54:57], 0
  v_mfma_f32_32x32x16_bf16 a[96:111], v[54:57], v[54:57], 0
  v_mfma_f32_32x32x16_bf16 a[112:127], v[54:57], v[54:57], 0
  v_mfma_f32_32x32x16_bf16 a[128:143], v[54:57], v[54:57], 0
  s_mul_i32 s45, s29, 32
  s_add_u32 s45, s45, s30
  s_mul_i32 s45, s45, 0x11000
  s_lshl_b32 s40, s28, 14
  s_add_u32 s45, s45, s40
  s_add_u32 s45, s45, 0xb84000
  v_lshrrev_b32 v36, 4, v1
  v_and_b32 v37, 15, v1
  s_mov_b32 s39, 0x2000
  v_mul_lo_u32 v38, v36, s39
  v_add_u32 v39, 0, v36
  v_lshlrev_b32 v39, 1, v39
  v_xor_b32 v39, v39, v37
  v_lshlrev_b32 v39, 4, v39
  v_add_u32 v40, v39, v38
  v_add_u32 v39, 0, v36
  v_lshlrev_b32 v39, 1, v39
  v_xor_b32 v39, v39, v37
  v_lshlrev_b32 v39, 4, v39
  v_add_u32 v41, v39, v38
  v_add_u32 v39, 4, v36
  v_lshlrev_b32 v39, 1, v39
  v_xor_b32 v39, v39, v37
  v_lshlrev_b32 v39, 4, v39
  v_add_u32 v42, v39, v38
  v_add_u32 v39, 4, v36
  v_lshlrev_b32 v39, 1, v39
  v_xor_b32 v39, v39, v37
  v_lshlrev_b32 v39, 4, v39
  v_add_u32 v43, v39, v38
  v_mov_b32 v2, v40
  v_add_u32 v3, 0x7c00, v41
  v_add_u32 v4, 0xf800, v42
  v_add_u32 v5, 0x17400, v43
  v_add_u32 v6, 0x20000, v40
  v_add_u32 v7, 0x27c00, v41
  v_add_u32 v8, 0x2f800, v42
  v_add_u32 v9, 0x37400, v43
  s_lshl_b32 s35, s32, 18
  s_lshl_b32 s40, s31, 8
  s_add_u32 s35, s35, s40
  s_cmp_ge_u32 s71, 32
  s_cbranch_scc1 M_no_slab_f
  v_lshlrev_b32 v140, 2, v45
  s_waitcnt vmcnt(8)
  v_accvgpr_read_b32 v139, a250
  v_lshlrev_b32 v148, 16, v139
  v_and_b32 v149, s46, v139
  v_mul_f32 v150, 0xbfb8aa3b, v148
  v_mul_f32 v151, 0xbfb8aa3b, v149
  v_exp_f32 v150, v150
  v_exp_f32 v151, v151
  v_add_f32 v150, 1.0, v150
  v_add_f32 v151, 1.0, v151
  v_rcp_f32 v150, v150
  v_rcp_f32 v151, v151
  v_mul_f32 v148, v148, v150
  v_mul_f32 v149, v149, v151
  v_cvt_pk_bf16_f32 v141, v148, v149
  v_add_u32 v136, 0xa000, v140
  ds_write_b32 v136, v141
  v_lshrrev_b32 v137, 2, v1
  v_lshlrev_b32 v137, 6, v137
  v_and_b32 v136, 3, v1
  v_lshl_add_u32 v136, v136, 3, v137
  v_add_u32 v143, s34, v136
  v_lshrrev_b32 v142, 4, v1
  v_lshlrev_b32 v142, 3, v142
  s_lshl_b32 s39, s28, 8
  s_add_u32 s39, s39, 0xa000
  v_add_u32 v142, s39, v142
  s_waitcnt lgkmcnt(0)
  s_barrier
  ds_read_b64 v[160:161], v142
  ds_read_b64 v[162:163], v142 offset:32
  ds_read_b64 v[164:165], v142 offset:64
  ds_read_b64 v[166:167], v142 offset:96
  ds_read_b64 v[168:169], v142 offset:128
  ds_read_b64 v[170:171], v142 offset:160
  ds_read_b64 v[172:173], v142 offset:192
  ds_read_b64 v[174:175], v142 offset:224
  s_waitcnt vmcnt(4)
  ds_read_b64_tr_b16 v[176:177], v143
  ds_read_b64_tr_b16 v[178:179], v143 offset:1024
  ds_read_b64_tr_b16 v[180:181], v143 offset:32
  ds_read_b64_tr_b16 v[182:183], v143 offset:1056
  ds_read_b64_tr_b16 v[184:185], v143 offset:2048
  ds_read_b64_tr_b16 v[186:187], v143 offset:3072
  ds_read_b64_tr_b16 v[188:189], v143 offset:2080
  s_waitcnt lgkmcnt(14)
  ds_read_b64_tr_b16 v[190:191], v143 offset:3104
  s_waitcnt lgkmcnt(6)
  v_mfma_f32_16x16x32_bf16 v[152:155], v[176:179], v[160:163], 0
  s_waitcnt lgkmcnt(4)
  v_mfma_f32_16x16x32_bf16 v[156:159], v[180:183], v[160:163], 0
  s_waitcnt lgkmcnt(2)
  v_mfma_f32_16x16x32_bf16 v[152:155], v[184:187], v[164:167], v[152:155]
  s_waitcnt lgkmcnt(0)
  v_mfma_f32_16x16x32_bf16 v[156:159], v[188:191], v[164:167], v[156:159]
  s_waitcnt vmcnt(0)
  ds_read_b64_tr_b16 v[176:177], v143 offset:4096
  ds_read_b64_tr_b16 v[178:179], v143 offset:5120
  ds_read_b64_tr_b16 v[180:181], v143 offset:4128
  ds_read_b64_tr_b16 v[182:183], v143 offset:5152
  ds_read_b64_tr_b16 v[184:185], v143 offset:6144
  ds_read_b64_tr_b16 v[186:187], v143 offset:7168
  ds_read_b64_tr_b16 v[188:189], v143 offset:6176
  ds_read_b64_tr_b16 v[190:191], v143 offset:7200
  s_waitcnt lgkmcnt(6)
  v_mfma_f32_16x16x32_bf16 v[152:155], v[176:179], v[168:171], v[152:155]
  s_waitcnt lgkmcnt(4)
  v_mfma_f32_16x16x32_bf16 v[156:159], v[180:183], v[168:171], v[156:159]
  s_waitcnt lgkmcnt(2)
  v_mfma_f32_16x16x32_bf16 v[152:155], v[184:187], v[172:175], v[152:155]
  s_waitcnt lgkmcnt(0)
  v_mfma_f32_16x16x32_bf16 v[156:159], v[188:191], v[172:175], v[156:159]
  v_lshrrev_b32 v137, 4, v1
  v_lshlrev_b32 v137, 4, v137
  s_lshl_b32 s39, s28, 7
  s_add_u32 s39, s39, 0xa400
  v_add_u32 v137, s39, v137
  s_nop 0
  ds_write_b128 v137, v[152:155]
  s_nop 0
  ds_write_b128 v137, v[156:159] offset:64
  s_waitcnt lgkmcnt(0)
  s_barrier
  s_cmp_lg_u32 s28, 0
  s_cbranch_scc1 M_slab0_done
  v_and_b32 v136, 31, v1
  v_lshlrev_b32 v136, 2, v136
  v_add_u32 v137, 0xa400, v136
  ds_read_b32 v152, v137
  ds_read_b32 v153, v137 offset:128
  ds_read_b32 v154, v137 offset:256
  ds_read_b32 v155, v137 offset:384
  s_waitcnt lgkmcnt(2)
  v_add_f32 v152, v152, v153
  s_waitcnt lgkmcnt(0)
  v_add_f32 v154, v154, v155
  v_add_f32 v152, v152, v154
  v_cvt_pk_bf16_f32 v152, v152, v152
  v_lshlrev_b32 v152, 16, v152
  v_add_f32 v153, 1.0, v152
  v_cvt_pk_bf16_f32 v153, v153, v153
  v_lshlrev_b32 v153, 16, v153
  s_lshr_b32 s39, s71, 4
  s_cmp_eq_u32 s39, 1
  s_cselect_b32 s40, 1, 0
  s_cmp_eq_u32 s39, 4
  s_cselect_b32 s40, 1, s40
  v_mov_b32 v138, s40
  v_cmp_eq_u32 vcc, 1, v138
  s_nop 1
  v_cndmask_b32 v152, v152, v153, vcc
  s_cmp_lt_u32 s39, 2
  s_mov_b32 s40, 0x3e0293ee
  s_cselect_b32 s40, s40, 1.0
  v_mul_f32 v152, s40, v152
  s_mov_b64 exec, 0xffffffff
  v_accvgpr_read_b32 v62, a253
  s_nop 0
  v_readfirstlane_b32 s90, v62
  s_nop 3
  s_add_u32 s90, s90, 1
  v_mov_b32 v153, s90
  v_lshlrev_b32 v136, 1, v136
  s_lshl_b32 s39, s71, 8
  s_add_u32 s39, s39, 0x4000
  buffer_store_dwordx2 v[152:153], v136, s[20:23], s39 offen sc1
  s_mov_b64 exec, -1
M_slab0_done:
  s_barrier
M_no_slab_f:
  s_cmp_ge_u32 s71, 0x60
  s_cbranch_scc1 M_x_done
  s_waitcnt vmcnt(15)
  buffer_load_dwordx4 v[64:67], v48, s[24:27], s91 offen
  s_add_u32 s91, s91, 64
  s_and_b32 s91, s91, 0x3ff
  s_waitcnt vmcnt(15)
  buffer_load_dwordx4 v[68:71], v48, s[24:27], s91 offen
  s_add_u32 s91, s91, 64
  s_and_b32 s91, s91, 0x3ff
  s_waitcnt vmcnt(15)
  buffer_load_dwordx4 v[72:75], v48, s[24:27], s91 offen
  s_add_u32 s91, s91, 64
  s_and_b32 s91, s91, 0x3ff
  s_waitcnt vmcnt(15)
  buffer_load_dwordx4 v[76:79], v48, s[24:27], s91 offen
  s_add_u32 s91, s91, 64
  s_and_b32 s91, s91, 0x3ff
  s_waitcnt vmcnt(15)
  buffer_load_dwordx4 v[80:83], v48, s[24:27], s91 offen
  s_add_u32 s91, s91, 64
  s_and_b32 s91, s91, 0x3ff
  s_waitcnt vmcnt(15)
  buffer_load_dwordx4 v[84:87], v48, s[24:27], s91 offen
  s_add_u32 s91, s91, 64
  s_and_b32 s91, s91, 0x3ff
  s_waitcnt vmcnt(15)
  buffer_load_dwordx4 v[88:91], v48, s[24:27], s91 offen
  s_add_u32 s91, s91, 64
  s_and_b32 s91, s91, 0x3ff
  s_waitcnt vmcnt(15)
  buffer_load_dwordx4 v[92:95], v48, s[24:27], s91 offen
  s_add_u32 s91, s91, 64
  s_and_b32 s91, s91, 0x3ff
  s_waitcnt vmcnt(15)
  buffer_load_dwordx4 v[96:99], v48, s[24:27], s91 offen
  s_add_u32 s91, s91, 64
  s_and_b32 s91, s91, 0x3ff
  s_waitcnt vmcnt(15)
  buffer_load_dwordx4 v[100:103], v48, s[24:27], s91 offen
  s_add_u32 s91, s91, 64
  s_and_b32 s91, s91, 0x3ff
  s_waitcnt vmcnt(15)
  buffer_load_dwordx4 v[104:107], v48, s[24:27], s91 offen
  s_add_u32 s91, s91, 64
  s_and_b32 s91, s91, 0x3ff
  s_waitcnt vmcnt(15)
  buffer_load_dwordx4 v[108:111], v48, s[24:27], s91 offen
  s_add_u32 s91, s91, 64
  s_and_b32 s91, s91, 0x3ff
  s_waitcnt vmcnt(15)
  buffer_load_dwordx4 v[112:115], v48, s[24:27], s91 offen
  s_add_u32 s91, s91, 64
  s_and_b32 s91, s91, 0x3ff
  s_waitcnt vmcnt(15)
  buffer_load_dwordx4 v[116:119], v48, s[24:27], s91 offen
  s_add_u32 s91, s91, 64
  s_and_b32 s91, s91, 0x3ff
  s_waitcnt vmcnt(15)
  buffer_load_dwordx4 v[120:123], v48, s[24:27], s91 offen
  s_add_u32 s91, s91, 64
  s_and_b32 s91, s91, 0x3ff
  s_waitcnt vmcnt(15)
  buffer_load_dwordx4 v[124:127], v48, s[24:27], s91 offen
M_x_done:
  s_add_u32 m0, s33, 0
  s_nop 0
  buffer_load_dwordx4 v2, s[4:7], s35 offen lds
  buffer_load_dwordx4 v3, s[4:7], s35 offen offset:1024 lds
  buffer_load_dwordx4 v4, s[4:7], s35 offen offset:2048 lds
  buffer_load_dwordx4 v5, s[4:7], s35 offen offset:3072 lds
  s_add_u32 m0, s33, 0x1000
  s_nop 0
  buffer_load_dwordx4 v6, s[4:7], s35 offen lds
  buffer_load_dwordx4 v7, s[4:7], s35 offen offset:1024 lds
  buffer_load_dwordx4 v8, s[4:7], s35 offen offset:2048 lds
  buffer_load_dwordx4 v9, s[4:7], s35 offen offset:3072 lds
  s_add_u32 s35, s35, 0x40000
  s_and_b32 s35, s35, 0x3fffff
  s_waitcnt vmcnt(23)
  v_mfma_f32_16x16x32_bf16 v[58:61], v[64:67], v[64:67], 0
  v_mfma_f32_16x16x32_bf16 a[232:235], v[50:53], v[64:67], 0
  s_waitcnt vmcnt(22)
  v_mfma_f32_16x16x32_bf16 v[58:61], v[68:71], v[68:71], v[58:61]
  v_mfma_f32_16x16x32_bf16 a[232:235], v[50:53], v[68:71], a[232:235]
  s_waitcnt vmcnt(21)
  v_mfma_f32_16x16x32_bf16 v[58:61], v[72:75], v[72:75], v[58:61]
  v_mfma_f32_16x16x32_bf16 a[232:235], v[50:53], v[72:75], a[232:235]
  s_waitcnt vmcnt(20)
  v_mfma_f32_16x16x32_bf16 v[58:61], v[76:79], v[76:79], v[58:61]
  v_mfma_f32_16x16x32_bf16 a[232:235], v[50:53], v[76:79], a[232:235]
  s_waitcnt vmcnt(19)
  v_mfma_f32_16x16x32_bf16 v[58:61], v[80:83], v[80:83], v[58:61]
  v_mfma_f32_16x16x32_bf16 a[232:235], v[50:53], v[80:83], a[232:235]
  s_waitcnt vmcnt(18)
  v_mfma_f32_16x16x32_bf16 v[58:61], v[84:87], v[84:87], v[58:61]
  v_mfma_f32_16x16x32_bf16 a[232:235], v[50:53], v[84:87], a[232:235]
  s_waitcnt vmcnt(17)
  v_mfma_f32_16x16x32_bf16 v[58:61], v[88:91], v[88:91], v[58:61]
  v_mfma_f32_16x16x32_bf16 a[232:235], v[50:53], v[88:91], a[232:235]
  s_waitcnt vmcnt(16)
  v_mfma_f32_16x16x32_bf16 v[58:61], v[92:95], v[92:95], v[58:61]
  v_mfma_f32_16x16x32_bf16 a[232:235], v[50:53], v[92:95], a[232:235]
  s_waitcnt vmcnt(15)
  v_mfma_f32_16x16x32_bf16 v[58:61], v[96:99], v[96:99], v[58:61]
  v_mfma_f32_16x16x32_bf16 a[232:235], v[50:53], v[96:99], a[232:235]
  s_waitcnt vmcnt(14)
  v_mfma_f32_16x16x32_bf16 v[58:61], v[100:103], v[100:103], v[58:61]
  v_mfma_f32_16x16x32_bf16 a[232:235], v[50:53], v[100:103], a[232:235]
  s_waitcnt vmcnt(13)
  v_mfma_f32_16x16x32_bf16 v[58:61], v[104:107], v[104:107], v[58:61]
  v_mfma_f32_16x16x32_bf16 a[232:235], v[50:53], v[104:107], a[232:235]
  s_waitcnt vmcnt(12)
  v_mfma_f32_16x16x32_bf16 v[58:61], v[108:111], v[108:111], v[58:61]
  v_mfma_f32_16x16x32_bf16 a[232:235], v[50:53], v[108:111], a[232:235]
  s_waitcnt vmcnt(11)
  v_mfma_f32_16x16x32_bf16 v[58:61], v[112:115], v[112:115], v[58:61]
  v_mfma_f32_16x16x32_bf16 a[232:235], v[50:53], v[112:115], a[232:235]
  s_waitcnt vmcnt(10)
  v_mfma_f32_16x16x32_bf16 v[58:61], v[116:119], v[116:119], v[58:61]
  v_mfma_f32_16x16x32_bf16 a[232:235], v[50:53], v[116:119], a[232:235]
  s_waitcnt vmcnt(9)
  v_mfma_f32_16x16x32_bf16 v[58:61], v[120:123], v[120:123], v[58:61]
  v_mfma_f32_16x16x32_bf16 a[232:235], v[50:53], v[120:123], a[232:235]
  s_waitcnt vmcnt(8)
  v_mfma_f32_16x16x32_bf16 v[58:61], v[124:127], v[124:127], v[58:61]
  v_mfma_f32_16x16x32_bf16 a[232:235], v[50:53], v[124:127], a[232:235]
  s_nop 7
  v_accvgpr_read_b32 v42, a232
  v_and_b32 v36, 3, v46
  v_cmp_eq_u32 vcc, 1, v36
  s_nop 1
  v_cndmask_b32 v37, v58, v59, vcc
  v_cmp_eq_u32 vcc, 2, v36
  s_nop 1
  v_cndmask_b32 v37, v37, v60, vcc
  v_cmp_eq_u32 vcc, 3, v36
  s_nop 1
  v_cndmask_b32 v37, v37, v61, vcc
  v_lshrrev_b32 v36, 2, v46
  v_cmp_eq_u32 vcc, v36, v47
  s_nop 1
  v_cndmask_b32 v37, 0, v37, vcc
  v_mov_b32 v36, v37
  s_nop 1
  v_permlane32_swap_b32 v37, v36
  v_add_f32 v37, v37, v36
  v_mov_b32 v36, v37
  s_nop 1
  v_permlane16_swap_b32 v37, v36
  v_add_f32 v37, v37, v36
  v_mul_f32 v43, 0x3b000000, v42
  v_mul_f32 v37, 0x3b000000, v37
  v_fma_f32 v37, -v43, v43, v37
  v_max_f32 v37, 0, v37
  v_add_f32 v37, 0x3727c5ac, v37
  v_rsq_f32 v50, v37
  s_nop 0
  v_mul_f32_e64 v52, -v43, v50
  v_mov_b32 v51, v50
  v_mov_b32 v53, v52
  v_lshlrev_b32 v128, 16, v64
  v_and_b32 v129, s46, v64
  v_lshlrev_b32 v130, 16, v65
  v_and_b32 v131, s46, v65
  v_lshlrev_b32 v132, 16, v66
  v_and_b32 v133, s46, v66
  v_lshlrev_b32 v134, 16, v67
  v_and_b32 v135, s46, v67
  v_pk_fma_f32 v[128:129], v[128:129], v[50:51], v[52:53]
  v_pk_fma_f32 v[130:131], v[130:131], v[50:51], v[52:53]
  v_pk_fma_f32 v[132:133], v[132:133], v[50:51], v[52:53]
  v_pk_fma_f32 v[134:135], v[134:135], v[50:51], v[52:53]
  v_lshlrev_b32 v136, 16, v68
  v_and_b32 v137, s46, v68
  v_lshlrev_b32 v138, 16, v69
  v_and_b32 v139, s46, v69
  v_lshlrev_b32 v140, 16, v70
  v_and_b32 v141, s46, v70
  v_lshlrev_b32 v142, 16, v71
  v_and_b32 v143, s46, v71
  v_pk_fma_f32 v[136:137], v[136:137], v[50:51], v[52:53]
  v_pk_fma_f32 v[138:139], v[138:139], v[50:51], v[52:53]
  v_pk_fma_f32 v[140:141], v[140:141], v[50:51], v[52:53]
  v_pk_fma_f32 v[142:143], v[142:143], v[50:51], v[52:53]
  v_lshlrev_b32 v144, 16, v72
  v_and_b32 v145, s46, v72
  v_lshlrev_b32 v146, 16, v73
  v_and_b32 v147, s46, v73
  v_lshlrev_b32 v148, 16, v74
  v_and_b32 v149, s46, v74
  v_lshlrev_b32 v150, 16, v75
  v_and_b32 v151, s46, v75
  v_pk_fma_f32 v[144:145], v[144:145], v[50:51], v[52:53]
  v_pk_fma_f32 v[146:147], v[146:147], v[50:51], v[52:53]
  v_pk_fma_f32 v[148:149], v[148:149], v[50:51], v[52:53]
  v_pk_fma_f32 v[150:151], v[150:151], v[50:51], v[52:53]
  v_lshlrev_b32 v152, 16, v76
  v_and_b32 v153, s46, v76
  v_lshlrev_b32 v154, 16, v77
  v_and_b32 v155, s46, v77
  v_lshlrev_b32 v156, 16, v78
  v_and_b32 v157, s46, v78
  v_lshlrev_b32 v158, 16, v79
  v_and_b32 v159, s46, v79
  v_pk_fma_f32 v[152:153], v[152:153], v[50:51], v[52:53]
  v_pk_fma_f32 v[154:155], v[154:155], v[50:51], v[52:53]
  v_pk_fma_f32 v[156:157], v[156:157], v[50:51], v[52:53]
  v_pk_fma_f32 v[158:159], v[158:159], v[50:51], v[52:53]
  v_lshlrev_b32 v160, 16, v80
  v_and_b32 v161, s46, v80
  v_lshlrev_b32 v162, 16, v81
  v_and_b32 v163, s46, v81
  v_lshlrev_b32 v164, 16, v82
  v_and_b32 v165, s46, v82
  v_lshlrev_b32 v166, 16, v83
  v_and_b32 v167, s46, v83
  v_pk_fma_f32 v[160:161], v[160:161], v[50:51], v[52:53]
  v_pk_fma_f32 v[162:163], v[162:163], v[50:51], v[52:53]
  v_pk_fma_f32 v[164:165], v[164:165], v[50:51], v[52:53]
  v_pk_fma_f32 v[166:167], v[166:167], v[50:51], v[52:53]
  v_lshlrev_b32 v168, 16, v84
  v_and_b32 v169, s46, v84
  v_lshlrev_b32 v170, 16, v85
  v_and_b32 v171, s46, v85
  v_lshlrev_b32 v172, 16, v86
  v_and_b32 v173, s46, v86
  v_lshlrev_b32 v174, 16, v87
  v_and_b32 v175, s46, v87
  v_pk_fma_f32 v[168:169], v[168:169], v[50:51], v[52:53]
  v_pk_fma_f32 v[170:171], v[170:171], v[50:51], v[52:53]
  v_pk_fma_f32 v[172:173], v[172:173], v[50:51], v[52:53]
  v_pk_fma_f32 v[174:175], v[174:175], v[50:51], v[52:53]
  v_lshlrev_b32 v176, 16, v88
  v_and_b32 v177, s46, v88
  v_lshlrev_b32 v178, 16, v89
  v_and_b32 v179, s46, v89
  v_lshlrev_b32 v180, 16, v90
  v_and_b32 v181, s46, v90
  v_lshlrev_b32 v182, 16, v91
  v_and_b32 v183, s46, v91
  v_pk_fma_f32 v[176:177], v[176:177], v[50:51], v[52:53]
  v_pk_fma_f32 v[178:179], v[178:179], v[50:51], v[52:53]
  v_pk_fma_f32 v[180:181], v[180:181], v[50:51], v[52:53]
  v_pk_fma_f32 v[182:183], v[182:183], v[50:51], v[52:53]
  v_lshlrev_b32 v184, 16, v92
  v_and_b32 v185, s46, v92
  v_lshlrev_b32 v186, 16, v93
  v_and_b32 v187, s46, v93
  v_lshlrev_b32 v188, 16, v94
  v_and_b32 v189, s46, v94
  v_lshlrev_b32 v190, 16, v95
  v_and_b32 v191, s46, v95
  v_pk_fma_f32 v[184:185], v[184:185], v[50:51], v[52:53]
  v_pk_fma_f32 v[186:187], v[186:187], v[50:51], v[52:53]
  v_pk_fma_f32 v[188:189], v[188:189], v[50:51], v[52:53]
  v_pk_fma_f32 v[190:191], v[190:191], v[50:51], v[52:53]
  v_lshlrev_b32 v192, 16, v96
  v_and_b32 v193, s46, v96
  v_lshlrev_b32 v194, 16, v97
  v_and_b32 v195, s46, v97
  v_lshlrev_b32 v196, 16, v98
  v_and_b32 v197, s46, v98
  v_lshlrev_b32 v198, 16, v99
  v_and_b32 v199, s46, v99
  v_pk_fma_f32 v[192:193], v[192:193], v[50:51], v[52:53]
  v_pk_fma_f32 v[194:195], v[194:195], v[50:51], v[52:53]
  v_pk_fma_f32 v[196:197], v[196:197], v[50:51], v[52:53]
  v_pk_fma_f32 v[198:199], v[198:199], v[50:51], v[52:53]
  v_lshlrev_b32 v200, 16, v100
  v_and_b32 v201, s46, v100
  v_lshlrev_b32 v202, 16, v101
  v_and_b32 v203, s46, v101
  v_lshlrev_b32 v204, 16, v102
  v_and_b32 v205, s46, v102
  v_lshlrev_b32 v206, 16, v103
  v_and_b32 v207, s46, v103
  v_pk_fma_f32 v[200:201], v[200:201], v[50:51], v[52:53]
  v_pk_fma_f32 v[202:203], v[202:203], v[50:51], v[52:53]
  v_pk_fma_f32 v[204:205], v[204:205], v[50:51], v[52:53]
  v_pk_fma_f32 v[206:207], v[206:207], v[50:51], v[52:53]
  v_lshlrev_b32 v208, 16, v104
  v_and_b32 v209, s46, v104
  v_lshlrev_b32 v210, 16, v105
  v_and_b32 v211, s46, v105
  v_lshlrev_b32 v212, 16, v106
  v_and_b32 v213, s46, v106
  v_lshlrev_b32 v214, 16, v107
  v_and_b32 v215, s46, v107
  v_pk_fma_f32 v[208:209], v[208:209], v[50:51], v[52:53]
  v_pk_fma_f32 v[210:211], v[210:211], v[50:51], v[52:53]
  v_pk_fma_f32 v[212:213], v[212:213], v[50:51], v[52:53]
  v_pk_fma_f32 v[214:215], v[214:215], v[50:51], v[52:53]
  v_lshlrev_b32 v216, 16, v108
  v_and_b32 v217, s46, v108
  v_lshlrev_b32 v218, 16, v109
  v_and_b32 v219, s46, v109
  v_lshlrev_b32 v220, 16, v110
  v_and_b32 v221, s46, v110
  v_lshlrev_b32 v222, 16, v111
  v_and_b32 v223, s46, v111
  v_pk_fma_f32 v[216:217], v[216:217], v[50:51], v[52:53]
  v_pk_fma_f32 v[218:219], v[218:219], v[50:51], v[52:53]
  v_pk_fma_f32 v[220:221], v[220:221], v[50:51], v[52:53]
  v_pk_fma_f32 v[222:223], v[222:223], v[50:51], v[52:53]
  v_lshlrev_b32 v224, 16, v112
  v_and_b32 v225, s46, v112
  v_lshlrev_b32 v226, 16, v113
  v_and_b32 v227, s46, v113
  v_lshlrev_b32 v228, 16, v114
  v_and_b32 v229, s46, v114
  v_lshlrev_b32 v230, 16, v115
  v_and_b32 v231, s46, v115
  v_pk_fma_f32 v[224:225], v[224:225], v[50:51], v[52:53]
  v_pk_fma_f32 v[226:227], v[226:227], v[50:51], v[52:53]
  v_pk_fma_f32 v[228:229], v[228:229], v[50:51], v[52:53]
  v_pk_fma_f32 v[230:231], v[230:231], v[50:51], v[52:53]
  v_lshlrev_b32 v232, 16, v116
  v_and_b32 v233, s46, v116
  v_lshlrev_b32 v234, 16, v117
  v_and_b32 v235, s46, v117
  v_lshlrev_b32 v236, 16, v118
  v_and_b32 v237, s46, v118
  v_lshlrev_b32 v238, 16, v119
  v_and_b32 v239, s46, v119
  v_pk_fma_f32 v[232:233], v[232:233], v[50:51], v[52:53]
  v_pk_fma_f32 v[234:235], v[234:235], v[50:51], v[52:53]
  v_pk_fma_f32 v[236:237], v[236:237], v[50:51], v[52:53]
  v_pk_fma_f32 v[238:239], v[238:239], v[50:51], v[52:53]
  v_lshlrev_b32 v240, 16, v120
  v_and_b32 v241, s46, v120
  v_lshlrev_b32 v242, 16, v121
  v_and_b32 v243, s46, v121
  v_lshlrev_b32 v244, 16, v122
  v_and_b32 v245, s46, v122
  v_lshlrev_b32 v246, 16, v123
  v_and_b32 v247, s46, v123
  v_pk_fma_f32 v[240:241], v[240:241], v[50:51], v[52:53]
  v_pk_fma_f32 v[242:243], v[242:243], v[50:51], v[52:53]
  v_pk_fma_f32 v[244:245], v[244:245], v[50:51], v[52:53]
  v_pk_fma_f32 v[246:247], v[246:247], v[50:51], v[52:53]
  v_lshlrev_b32 v248, 16, v124
  v_and_b32 v249, s46, v124
  v_lshlrev_b32 v250, 16, v125
  v_and_b32 v251, s46, v125
  v_lshlrev_b32 v252, 16, v126
  v_and_b32 v253, s46, v126
  v_lshlrev_b32 v254, 16, v127
  v_and_b32 v255, s46, v127
  v_pk_fma_f32 v[248:249], v[248:249], v[50:51], v[52:53]
  v_pk_fma_f32 v[250:251], v[250:251], v[50:51], v[52:53]
  v_pk_fma_f32 v[252:253], v[252:253], v[50:51], v[52:53]
  v_pk_fma_f32 v[254:255], v[254:255], v[50:51], v[52:53]
  s_sub_u32 s44, s71, 32
  s_cmp_ge_u32 s44, 64
  s_cbranch_scc1 M_no_slab1
  v_lshlrev_b32 v68, 2, v45
  v_accvgpr_read_b32 v67, a250
  v_lshlrev_b32 v76, 16, v67
  v_and_b32 v77, s46, v67
  v_mul_f32 v78, 0xbfb8aa3b, v76
  v_mul_f32 v79, 0xbfb8aa3b, v77
  v_exp_f32 v78, v78
  v_exp_f32 v79, v79
  v_add_f32 v78, 1.0, v78
  v_add_f32 v79, 1.0, v79
  v_rcp_f32 v78, v78
  v_rcp_f32 v79, v79
  v_mul_f32 v76, v76, v78
  v_mul_f32 v77, v77, v79
  v_cvt_pk_bf16_f32 v69, v76, v77
  v_add_u32 v64, 0xa000, v68
  ds_write_b32 v64, v69
  v_lshrrev_b32 v65, 2, v1
  v_lshlrev_b32 v65, 6, v65
  v_and_b32 v64, 3, v1
  v_lshl_add_u32 v64, v64, 3, v65
  v_add_u32 v71, s34, v64
  v_lshrrev_b32 v70, 4, v1
  v_lshlrev_b32 v70, 3, v70
  s_lshl_b32 s39, s28, 8
  s_add_u32 s39, s39, 0xa000
  v_add_u32 v70, s39, v70
  s_waitcnt lgkmcnt(0)
  s_barrier
  ds_read_b64 v[88:89], v70
  ds_read_b64 v[90:91], v70 offset:32
  ds_read_b64 v[92:93], v70 offset:64
  ds_read_b64 v[94:95], v70 offset:96
  ds_read_b64 v[96:97], v70 offset:128
  ds_read_b64 v[98:99], v70 offset:160
  ds_read_b64 v[100:101], v70 offset:192
  ds_read_b64 v[102:103], v70 offset:224
  ds_read_b64_tr_b16 v[104:105], v71
  ds_read_b64_tr_b16 v[106:107], v71 offset:1024
  ds_read_b64_tr_b16 v[108:109], v71 offset:32
  ds_read_b64_tr_b16 v[110:111], v71 offset:1056
  ds_read_b64_tr_b16 v[112:113], v71 offset:2048
  ds_read_b64_tr_b16 v[114:115], v71 offset:3072
  ds_read_b64_tr_b16 v[116:117], v71 offset:2080
  s_waitcnt lgkmcnt(14)
  ds_read_b64_tr_b16 v[118:119], v71 offset:3104
  s_waitcnt lgkmcnt(6)
  v_mfma_f32_16x16x32_bf16 v[80:83], v[104:107], v[88:91], 0
  s_waitcnt lgkmcnt(4)
  v_mfma_f32_16x16x32_bf16 v[84:87], v[108:111], v[88:91], 0
  s_waitcnt lgkmcnt(2)
  v_mfma_f32_16x16x32_bf16 v[80:83], v[112:115], v[92:95], v[80:83]
  s_waitcnt lgkmcnt(0)
  v_mfma_f32_16x16x32_bf16 v[84:87], v[116:119], v[92:95], v[84:87]
  ds_read_b64_tr_b16 v[104:105], v71 offset:4096
  ds_read_b64_tr_b16 v[106:107], v71 offset:5120
  ds_read_b64_tr_b16 v[108:109], v71 offset:4128
  ds_read_b64_tr_b16 v[110:111], v71 offset:5152
  ds_read_b64_tr_b16 v[112:113], v71 offset:6144
  ds_read_b64_tr_b16 v[114:115], v71 offset:7168
  ds_read_b64_tr_b16 v[116:117], v71 offset:6176
  ds_read_b64_tr_b16 v[118:119], v71 offset:7200
  s_waitcnt lgkmcnt(6)
  v_mfma_f32_16x16x32_bf16 v[80:83], v[104:107], v[96:99], v[80:83]
  s_waitcnt lgkmcnt(4)
  v_mfma_f32_16x16x32_bf16 v[84:87], v[108:111], v[96:99], v[84:87]
  s_waitcnt lgkmcnt(2)
  v_mfma_f32_16x16x32_bf16 v[80:83], v[112:115], v[100:103], v[80:83]
  s_waitcnt lgkmcnt(0)
  v_mfma_f32_16x16x32_bf16 v[84:87], v[116:119], v[100:103], v[84:87]
  v_lshrrev_b32 v65, 4, v1
  v_lshlrev_b32 v65, 4, v65
  s_lshl_b32 s39, s28, 7
  s_add_u32 s39, s39, 0xa400
  v_add_u32 v65, s39, v65
  s_nop 0
  ds_write_b128 v65, v[80:83]
  s_nop 0
  ds_write_b128 v65, v[84:87] offset:64
  s_waitcnt lgkmcnt(0)
  s_barrier
  s_cmp_lg_u32 s28, 3
  s_cbranch_scc1 M_slab1_done
  v_and_b32 v64, 31, v1
  v_lshlrev_b32 v64, 2, v64
  v_add_u32 v65, 0xa400, v64
  ds_read_b32 v80, v65
  ds_read_b32 v81, v65 offset:128
  ds_read_b32 v82, v65 offset:256
  ds_read_b32 v83, v65 offset:384
  s_waitcnt lgkmcnt(2)
  v_add_f32 v80, v80, v81
  s_waitcnt lgkmcnt(0)
  v_add_f32 v82, v82, v83
  v_add_f32 v80, v80, v82
  v_cvt_pk_bf16_f32 v80, v80, v80
  v_lshlrev_b32 v80, 16, v80
  v_add_f32 v81, 1.0, v80
  v_cvt_pk_bf16_f32 v81, v81, v81
  v_lshlrev_b32 v81, 16, v81
  s_lshr_b32 s39, s71, 4
  s_cmp_eq_u32 s39, 1
  s_cselect_b32 s40, 1, 0
  s_cmp_eq_u32 s39, 4
  s_cselect_b32 s40, 1, s40
  v_mov_b32 v66, s40
  v_cmp_eq_u32 vcc, 1, v66
  s_nop 1
  v_cndmask_b32 v80, v80, v81, vcc
  s_cmp_lt_u32 s39, 2
  s_mov_b32 s40, 0x3e0293ee
  s_cselect_b32 s40, s40, 1.0
  v_mul_f32 v80, s40, v80
  s_mov_b64 exec, 0xffffffff
  s_lshl_b32 s39, s71, 7
  s_add_u32 s39, s39, 0
  buffer_store_dword v80, v64, s[20:23], s39 offen sc1
  s_mov_b64 exec, -1
M_slab1_done:
M_no_slab1:
  s_lshl_b32 s40, s28, 2
  s_add_u32 s40, s40, s32
  v_add_u32 v36, s40, v47
  v_and_b32 v36, 15, v36
  v_lshlrev_b32 v36, 8, v36
  v_lshrrev_b32 v37, 3, v46
  v_lshl_add_u32 v36, v37, 12, v36
  v_and_b32 v37, 7, v46
  v_lshl_add_u32 v41, v37, 5, v36
  v_accvgpr_read_b32 v62, a253
  s_nop 0
  v_readfirstlane_b32 s90, v62
  s_nop 3
  s_add_u32 s90, s90, 1
  s_mov_b32 s51, 0
  s_mov_b32 s40, 0x4000
P_modg:
  buffer_load_dwordx4 v[64:67], v41, s[20:23], s40 offen sc1
  buffer_load_dwordx4 v[68:71], v41, s[20:23], s40 offen offset:16 sc1
  s_waitcnt vmcnt(1)
  v_cmp_eq_u32 vcc, s90, v65
  s_nop 3
  s_mov_b64 s[48:49], vcc
  v_cmp_eq_u32 vcc, s90, v67
  s_nop 3
  s_and_b64 s[48:49], s[48:49], vcc
  s_waitcnt vmcnt(0)
  v_cmp_eq_u32 vcc, s90, v69
  s_nop 3
  s_and_b64 s[48:49], s[48:49], vcc
  v_cmp_eq_u32 vcc, s90, v71
  s_nop 3
  s_and_b64 s[48:49], s[48:49], vcc
  s_cmp_eq_u64 s[48:49], exec
  s_cbranch_scc1 P_modg_done
  s_add_u32 s51, s51, 1
  s_cmp_lt_u32 s51, 0x40000
  s_sleep 1
  s_cbranch_scc1 P_modg
P_modg_done:
  s_add_u32 m0, s33, 0x2000
  s_nop 0
  buffer_load_dwordx4 v2, s[4:7], s35 offen lds
  buffer_load_dwordx4 v3, s[4:7], s35 offen offset:1024 lds
  buffer_load_dwordx4 v4, s[4:7], s35 offen offset:2048 lds
  buffer_load_dwordx4 v5, s[4:7], s35 offen offset:3072 lds
  s_add_u32 m0, s33, 0x3000
  s_nop 0
  buffer_load_dwordx4 v6, s[4:7], s35 offen lds
  buffer_load_dwordx4 v7, s[4:7], s35 offen offset:1024 lds
  buffer_load_dwordx4 v8, s[4:7], s35 offen offset:2048 lds
  buffer_load_dwordx4 v9, s[4:7], s35 offen offset:3072 lds
  s_add_u32 s35, s35, 0x40000
  s_and_b32 s35, s35, 0x3fffff
  s_cmp_eq_u32 s28, 0
  s_cbranch_scc1 M_no_touch
  v_lshlrev_b32 v42, 6, v1
  s_cmp_lt_u32 s30, 16
  s_cselect_b32 s92, s76, s78
  s_cselect_b32 s93, s77, s79
  s_lshl_b32 s40, s29, 21
  s_add_u32 s40, s40, 0x60000
  s_add_u32 s92, s92, s40
  s_addc_u32 s93, s93, 0
  s_mov_b32 s94, 0x200000
  s_mov_b32 s95, 0x20000
  s_lshl_b32 s41, s32, 13
  s_add_u32 s40, s28, -1
  s_lshr_b32 s42, s40, 1
  s_lshl_b32 s42, s42, 19
  s_and_b32 s40, s40, 1
  s_lshl_b32 s40, s40, 12
  s_add_u32 s40, s40, s42
  s_add_u32 s40, s40, s41
  buffer_load_dword a240, v42, s[92:95], s40 offen
  s_add_u32 s40, s28, 2
  s_lshr_b32 s42, s40, 1
  s_lshl_b32 s42, s42, 19
  s_and_b32 s40, s40, 1
  s_lshl_b32 s40, s40, 12
  s_add_u32 s40, s40, s42
  s_add_u32 s40, s40, s41
  buffer_load_dword a241, v42, s[92:95], s40 offen
  s_add_u32 s40, s28, 5
  s_lshr_b32 s42, s40, 1
  s_lshl_b32 s42, s42, 19
  s_and_b32 s40, s40, 1
  s_lshl_b32 s40, s40, 12
  s_add_u32 s40, s40, s42
  s_add_u32 s40, s40, s41
  buffer_load_dword a242, v42, s[92:95], s40 offen
  s_mov_b32 s92, s82
  s_mov_b32 s93, s83
  s_cmp_eq_u32 s28, 2
  s_cselect_b32 s92, s84, s92
  s_cmp_eq_u32 s28, 2
  s_cselect_b32 s93, s85, s93
  s_cmp_eq_u32 s28, 3
  s_cselect_b32 s92, s86, s92
  s_cmp_eq_u32 s28, 3
  s_cselect_b32 s93, s87, s93
  s_mov_b32 s94, 0x158000
  s_lshl_b32 s41, s2, 12
  buffer_load_dword a243, v42, s[92:95], s41 offen
  s_add_u32 s41, s41, 0x100000
  buffer_load_dword a244, v42, s[92:95], s41 offen
M_no_touch:
  v_mov_b32 v65, v66
  v_mov_b32 v66, v68
  v_mov_b32 v67, v70
  s_lshl_b32 s40, s28, 10
  s_add_u32 s40, s40, 0x4000
  v_add_u32 v40, s40, v35
  ds_write_b128 v40, v[64:67]
  v_lshlrev_b32 v38, 5, v47
  v_add_u32 v38, 0x4000, v38
  s_lshl_b32 s40, s28, 10
  s_add_u32 s40, s40, 0x18000
  v_add_u32 v39, s40, v35
  s_waitcnt lgkmcnt(0)
  s_barrier
  ds_read_b128 v[64:67], v38
  ds_read_b128 v[68:71], v38 offset:16
  ds_read_b128 v[72:75], v38 offset:128
  ds_read_b128 v[76:79], v38 offset:144
  ds_read_b128 v[80:83], v38 offset:256
  ds_read_b128 v[84:87], v38 offset:272
  ds_read_b128 v[88:91], v38 offset:384
  ds_read_b128 v[92:95], v38 offset:400
  ds_read_b128 v[96:99], v38 offset:512
  ds_read_b128 v[100:103], v38 offset:528
  ds_read_b128 v[104:107], v38 offset:640
  ds_read_b128 v[108:111], v38 offset:656
  s_waitcnt lgkmcnt(9)
  v_pk_fma_f32 v[128:129], v[128:129], v[72:73], v[64:65]
  v_pk_fma_f32 v[130:131], v[130:131], v[74:75], v[66:67]
  s_waitcnt lgkmcnt(8)
  v_pk_fma_f32 v[132:133], v[132:133], v[76:77], v[68:69]
  v_pk_fma_f32 v[134:135], v[134:135], v[78:79], v[70:71]
  v_cvt_pk_bf16_f32 v112, v128, v129
  v_cvt_pk_bf16_f32 v113, v130, v131
  v_cvt_pk_bf16_f32 v114, v132, v133
  v_cvt_pk_bf16_f32 v115, v134, v135
  ds_write_b128 v39, v[112:115]
  ds_read_b128 v[64:67], v38 offset:768
  ds_read_b128 v[68:71], v38 offset:784
  ds_read_b128 v[72:75], v38 offset:896
  ds_read_b128 v[76:79], v38 offset:912
  s_waitcnt lgkmcnt(10)
  v_pk_fma_f32 v[136:137], v[136:137], v[88:89], v[80:81]
  v_pk_fma_f32 v[138:139], v[138:139], v[90:91], v[82:83]
  s_waitcnt lgkmcnt(9)
  v_pk_fma_f32 v[140:141], v[140:141], v[92:93], v[84:85]
  v_pk_fma_f32 v[142:143], v[142:143], v[94:95], v[86:87]
  v_cvt_pk_bf16_f32 v116, v136, v137
  v_cvt_pk_bf16_f32 v117, v138, v139
  v_cvt_pk_bf16_f32 v118, v140, v141
  v_cvt_pk_bf16_f32 v119, v142, v143
  ds_write_b128 v39, v[116:119] offset:4096
  ds_read_b128 v[80:83], v38 offset:1024
  ds_read_b128 v[84:87], v38 offset:1040
  ds_read_b128 v[88:91], v38 offset:1152
  ds_read_b128 v[92:95], v38 offset:1168
  s_waitcnt lgkmcnt(11)
  v_pk_fma_f32 v[144:145], v[144:145], v[104:105], v[96:97]
  v_pk_fma_f32 v[146:147], v[146:147], v[106:107], v[98:99]
  s_waitcnt lgkmcnt(10)
  v_pk_fma_f32 v[148:149], v[148:149], v[108:109], v[100:101]
  v_pk_fma_f32 v[150:151], v[150:151], v[110:111], v[102:103]
  v_cvt_pk_bf16_f32 v120, v144, v145
  v_cvt_pk_bf16_f32 v121, v146, v147
  v_cvt_pk_bf16_f32 v122, v148, v149
  v_cvt_pk_bf16_f32 v123, v150, v151
  ds_write_b128 v39, v[120:123] offset:8192
  ds_read_b128 v[96:99], v38 offset:1280
  ds_read_b128 v[100:103], v38 offset:1296
  ds_read_b128 v[104:107], v38 offset:1408
  ds_read_b128 v[108:111], v38 offset:1424
  s_waitcnt lgkmcnt(11)
  v_pk_fma_f32 v[152:153], v[152:153], v[72:73], v[64:65]
  v_pk_fma_f32 v[154:155], v[154:155], v[74:75], v[66:67]
  s_waitcnt lgkmcnt(10)
  v_pk_fma_f32 v[156:157], v[156:157], v[76:77], v[68:69]
  v_pk_fma_f32 v[158:159], v[158:159], v[78:79], v[70:71]
  v_cvt_pk_bf16_f32 v124, v152, v153
  v_cvt_pk_bf16_f32 v125, v154, v155
  v_cvt_pk_bf16_f32 v126, v156, v157
  v_cvt_pk_bf16_f32 v127, v158, v159
  ds_write_b128 v39, v[124:127] offset:12288
  ds_read_b128 v[64:67], v38 offset:1536
  ds_read_b128 v[68:71], v38 offset:1552
  ds_read_b128 v[72:75], v38 offset:1664
  ds_read_b128 v[76:79], v38 offset:1680
  s_waitcnt lgkmcnt(11)
  v_pk_fma_f32 v[160:161], v[160:161], v[88:89], v[80:81]
  v_pk_fma_f32 v[162:163], v[162:163], v[90:91], v[82:83]
  s_waitcnt lgkmcnt(10)
  v_pk_fma_f32 v[164:165], v[164:165], v[92:93], v[84:85]
  v_pk_fma_f32 v[166:167], v[166:167], v[94:95], v[86:87]
  v_cvt_pk_bf16_f32 v112, v160, v161
  v_cvt_pk_bf16_f32 v113, v162, v163
  v_cvt_pk_bf16_f32 v114, v164, v165
  v_cvt_pk_bf16_f32 v115, v166, v167
  ds_write_b128 v39, v[112:115] offset:16384
  ds_read_b128 v[80:83], v38 offset:1792
  ds_read_b128 v[84:87], v38 offset:1808
  ds_read_b128 v[88:91], v38 offset:1920
  ds_read_b128 v[92:95], v38 offset:1936
  s_waitcnt lgkmcnt(11)
  v_pk_fma_f32 v[168:169], v[168:169], v[104:105], v[96:97]
  v_pk_fma_f32 v[170:171], v[170:171], v[106:107], v[98:99]
  s_waitcnt lgkmcnt(10)
  v_pk_fma_f32 v[172:173], v[172:173], v[108:109], v[100:101]
  v_pk_fma_f32 v[174:175], v[174:175], v[110:111], v[102:103]
  v_cvt_pk_bf16_f32 v116, v168, v169
  v_cvt_pk_bf16_f32 v117, v170, v171
  v_cvt_pk_bf16_f32 v118, v172, v173
  v_cvt_pk_bf16_f32 v119, v174, v175
  ds_write_b128 v39, v[116:119] offset:20480
  ds_read_b128 v[96:99], v38 offset:2048
  ds_read_b128 v[100:103], v38 offset:2064
  ds_read_b128 v[104:107], v38 offset:2176
  ds_read_b128 v[108:111], v38 offset:2192
  s_waitcnt lgkmcnt(11)
  v_pk_fma_f32 v[176:177], v[176:177], v[72:73], v[64:65]
  v_pk_fma_f32 v[178:179], v[178:179], v[74:75], v[66:67]
  s_waitcnt lgkmcnt(10)
  v_pk_fma_f32 v[180:181], v[180:181], v[76:77], v[68:69]
  v_pk_fma_f32 v[182:183], v[182:183], v[78:79], v[70:71]
  v_cvt_pk_bf16_f32 v120, v176, v177
  v_cvt_pk_bf16_f32 v121, v178, v179
  v_cvt_pk_bf16_f32 v122, v180, v181
  v_cvt_pk_bf16_f32 v123, v182, v183
  ds_write_b128 v39, v[120:123] offset:24576
  ds_read_b128 v[64:67], v38 offset:2304
  ds_read_b128 v[68:71], v38 offset:2320
  ds_read_b128 v[72:75], v38 offset:2432
  ds_read_b128 v[76:79], v38 offset:2448
  s_waitcnt lgkmcnt(11)
  v_pk_fma_f32 v[184:185], v[184:185], v[88:89], v[80:81]
  v_pk_fma_f32 v[186:187], v[186:187], v[90:91], v[82:83]
  s_waitcnt lgkmcnt(10)
  v_pk_fma_f32 v[188:189], v[188:189], v[92:93], v[84:85]
  v_pk_fma_f32 v[190:191], v[190:191], v[94:95], v[86:87]
  v_cvt_pk_bf16_f32 v124, v184, v185
  v_cvt_pk_bf16_f32 v125, v186, v187
  v_cvt_pk_bf16_f32 v126, v188, v189
  v_cvt_pk_bf16_f32 v127, v190, v191
  ds_write_b128 v39, v[124:127] offset:28672
  ds_read_b128 v[80:83], v38 offset:2560
  ds_read_b128 v[84:87], v38 offset:2576
  ds_read_b128 v[88:91], v38 offset:2688
  ds_read_b128 v[92:95], v38 offset:2704
  s_waitcnt lgkmcnt(11)
  v_pk_fma_f32 v[192:193], v[192:193], v[104:105], v[96:97]
  v_pk_fma_f32 v[194:195], v[194:195], v[106:107], v[98:99]
  s_waitcnt lgkmcnt(10)
  v_pk_fma_f32 v[196:197], v[196:197], v[108:109], v[100:101]
  v_pk_fma_f32 v[198:199], v[198:199], v[110:111], v[102:103]
  v_cvt_pk_bf16_f32 v112, v192, v193
  v_cvt_pk_bf16_f32 v113, v194, v195
  v_cvt_pk_bf16_f32 v114, v196, v197
  v_cvt_pk_bf16_f32 v115, v198, v199
  ds_write_b128 v39, v[112:115] offset:32768
  ds_read_b128 v[96:99], v38 offset:2816
  ds_read_b128 v[100:103], v38 offset:2832
  ds_read_b128 v[104:107], v38 offset:2944
  ds_read_b128 v[108:111], v38 offset:2960
  s_waitcnt lgkmcnt(11)
  v_pk_fma_f32 v[200:201], v[200:201], v[72:73], v[64:65]
  v_pk_fma_f32 v[202:203], v[202:203], v[74:75], v[66:67]
  s_waitcnt lgkmcnt(10)
  v_pk_fma_f32 v[204:205], v[204:205], v[76:77], v[68:69]
  v_pk_fma_f32 v[206:207], v[206:207], v[78:79], v[70:71]
  v_cvt_pk_bf16_f32 v116, v200, v201
  v_cvt_pk_bf16_f32 v117, v202, v203
  v_cvt_pk_bf16_f32 v118, v204, v205
  v_cvt_pk_bf16_f32 v119, v206, v207
  ds_write_b128 v39, v[116:119] offset:36864
  ds_read_b128 v[64:67], v38 offset:3072
  ds_read_b128 v[68:71], v38 offset:3088
  ds_read_b128 v[72:75], v38 offset:3200
  ds_read_b128 v[76:79], v38 offset:3216
  s_waitcnt lgkmcnt(11)
  v_pk_fma_f32 v[208:209], v[208:209], v[88:89], v[80:81]
  v_pk_fma_f32 v[210:211], v[210:211], v[90:91], v[82:83]
  s_waitcnt lgkmcnt(10)
  v_pk_fma_f32 v[212:213], v[212:213], v[92:93], v[84:85]
  v_pk_fma_f32 v[214:215], v[214:215], v[94:95], v[86:87]
  v_cvt_pk_bf16_f32 v120, v208, v209
  v_cvt_pk_bf16_f32 v121, v210, v211
  v_cvt_pk_bf16_f32 v122, v212, v213
  v_cvt_pk_bf16_f32 v123, v214, v215
  ds_write_b128 v39, v[120:123] offset:40960
  ds_read_b128 v[80:83], v38 offset:3328
  ds_read_b128 v[84:87], v38 offset:3344
  ds_read_b128 v[88:91], v38 offset:3456
  ds_read_b128 v[92:95], v38 offset:3472
  s_waitcnt lgkmcnt(11)
  v_pk_fma_f32 v[216:217], v[216:217], v[104:105], v[96:97]
  v_pk_fma_f32 v[218:219], v[218:219], v[106:107], v[98:99]
  s_waitcnt lgkmcnt(10)
  v_pk_fma_f32 v[220:221], v[220:221], v[108:109], v[100:101]
  v_pk_fma_f32 v[222:223], v[222:223], v[110:111], v[102:103]
  v_cvt_pk_bf16_f32 v124, v216, v217
  v_cvt_pk_bf16_f32 v125, v218, v219
  v_cvt_pk_bf16_f32 v126, v220, v221
  v_cvt_pk_bf16_f32 v127, v222, v223
  ds_write_b128 v39, v[124:127] offset:45056
  ds_read_b128 v[96:99], v38 offset:3584
  ds_read_b128 v[100:103], v38 offset:3600
  ds_read_b128 v[104:107], v38 offset:3712
  ds_read_b128 v[108:111], v38 offset:3728
  s_waitcnt lgkmcnt(11)
  v_pk_fma_f32 v[224:225], v[224:225], v[72:73], v[64:65]
  v_pk_fma_f32 v[226:227], v[226:227], v[74:75], v[66:67]
  s_waitcnt lgkmcnt(10)
  v_pk_fma_f32 v[228:229], v[228:229], v[76:77], v[68:69]
  v_pk_fma_f32 v[230:231], v[230:231], v[78:79], v[70:71]
  v_cvt_pk_bf16_f32 v112, v224, v225
  v_cvt_pk_bf16_f32 v113, v226, v227
  v_cvt_pk_bf16_f32 v114, v228, v229
  v_cvt_pk_bf16_f32 v115, v230, v231
  ds_write_b128 v39, v[112:115] offset:49152
  ds_read_b128 v[64:67], v38 offset:3840
  ds_read_b128 v[68:71], v38 offset:3856
  ds_read_b128 v[72:75], v38 offset:3968
  ds_read_b128 v[76:79], v38 offset:3984
  s_waitcnt lgkmcnt(11)
  v_pk_fma_f32 v[232:233], v[232:233], v[88:89], v[80:81]
  v_pk_fma_f32 v[234:235], v[234:235], v[90:91], v[82:83]
  s_waitcnt lgkmcnt(10)
  v_pk_fma_f32 v[236:237], v[236:237], v[92:93], v[84:85]
  v_pk_fma_f32 v[238:239], v[238:239], v[94:95], v[86:87]
  v_cvt_pk_bf16_f32 v116, v232, v233
  v_cvt_pk_bf16_f32 v117, v234, v235
  v_cvt_pk_bf16_f32 v118, v236, v237
  v_cvt_pk_bf16_f32 v119, v238, v239
  ds_write_b128 v39, v[116:119] offset:53248
  s_waitcnt lgkmcnt(7)
  v_pk_fma_f32 v[240:241], v[240:241], v[104:105], v[96:97]
  v_pk_fma_f32 v[242:243], v[242:243], v[106:107], v[98:99]
  s_waitcnt lgkmcnt(6)
  v_pk_fma_f32 v[244:245], v[244:245], v[108:109], v[100:101]
  v_pk_fma_f32 v[246:247], v[246:247], v[110:111], v[102:103]
  v_cvt_pk_bf16_f32 v120, v240, v241
  v_cvt_pk_bf16_f32 v121, v242, v243
  v_cvt_pk_bf16_f32 v122, v244, v245
  v_cvt_pk_bf16_f32 v123, v246, v247
  ds_write_b128 v39, v[120:123] offset:57344
  s_waitcnt lgkmcnt(3)
  v_pk_fma_f32 v[248:249], v[248:249], v[72:73], v[64:65]
  v_pk_fma_f32 v[250:251], v[250:251], v[74:75], v[66:67]
  s_waitcnt lgkmcnt(2)
  v_pk_fma_f32 v[252:253], v[252:253], v[76:77], v[68:69]
  v_pk_fma_f32 v[254:255], v[254:255], v[78:79], v[70:71]
  v_cvt_pk_bf16_f32 v124, v248, v249
  v_cvt_pk_bf16_f32 v125, v250, v251
  v_cvt_pk_bf16_f32 v126, v252, v253
  v_cvt_pk_bf16_f32 v127, v254, v255
  ds_write_b128 v39, v[124:127] offset:61440
  v_mfma_f32_32x32x16_bf16 v[128:143], v[54:57], v[54:57], 0
  v_mfma_f32_32x32x16_bf16 v[144:159], v[54:57], v[54:57], 0
  v_mfma_f32_32x32x16_bf16 v[160:175], v[54:57], v[54:57], 0
  v_mfma_f32_32x32x16_bf16 v[176:191], v[54:57], v[54:57], 0
  v_mfma_f32_32x32x16_bf16 v[192:207], v[54:57], v[54:57], 0
  v_mfma_f32_32x32x16_bf16 v[208:223], v[54:57], v[54:57], 0
  v_mfma_f32_32x32x16_bf16 v[224:239], v[54:57], v[54:57], 0
  v_mfma_f32_32x32x16_bf16 v[240:255], v[54:57], v[54:57], 0
  s_waitcnt lgkmcnt(0)
  s_barrier
  ds_read_b128 a[180:183], v34
  ds_read_b128 a[184:187], v34 offset:1024
  ds_read_b128 a[188:191], v34 offset:2048
  ds_read_b128 a[192:195], v34 offset:3072
  ds_read_b64_tr_b16 a[148:149], v22
  ds_read_b64_tr_b16 a[150:151], v22 offset:1024
  ds_read_b64_tr_b16 a[152:153], v23
  ds_read_b64_tr_b16 a[154:155], v23 offset:1024
  s_mov_b32 s38, 4
L_gq_1:
  s_waitcnt lgkmcnt(0)
  v_mfma_f32_16x16x32_bf16 v[128:131], a[148:151], a[180:183], v[128:131]
  ds_read_b64_tr_b16 a[156:157], v24
  v_mfma_f32_16x16x32_bf16 v[132:135], a[148:151], a[184:187], v[132:135]
  ds_read_b64_tr_b16 a[158:159], v24 offset:1024
  s_add_u32 m0, s33, 0x4000
  v_mfma_f32_16x16x32_bf16 v[136:139], a[148:151], a[188:191], v[136:139]
  buffer_load_dwordx4 v2, s[4:7], s35 offen lds
  v_mfma_f32_16x16x32_bf16 v[140:143], a[148:151], a[192:195], v[140:143]
  ds_read_b64_tr_b16 a[160:161], v25
  v_mfma_f32_16x16x32_bf16 v[144:147], a[152:155], a[180:183], v[144:147]
  ds_read_b64_tr_b16 a[162:163], v25 offset:1024
  v_mfma_f32_16x16x32_bf16 v[148:151], a[152:155], a[184:187], v[148:151]
  ds_read_b128 a[196:199], v34 offset:4096
  v_mfma_f32_16x16x32_bf16 v[152:155], a[152:155], a[188:191], v[152:155]
  buffer_load_dwordx4 v3, s[4:7], s35 offen offset:1024 lds
  v_mfma_f32_16x16x32_bf16 v[156:159], a[152:155], a[192:195], v[156:159]
  s_waitcnt lgkmcnt(1)
  v_mfma_f32_16x16x32_bf16 v[160:163], a[156:159], a[180:183], v[160:163]
  ds_read_b64_tr_b16 a[148:149], v26
  v_mfma_f32_16x16x32_bf16 v[164:167], a[156:159], a[184:187], v[164:167]
  ds_read_b64_tr_b16 a[150:151], v26 offset:1024
  v_mfma_f32_16x16x32_bf16 v[168:171], a[156:159], a[188:191], v[168:171]
  buffer_load_dwordx4 v4, s[4:7], s35 offen offset:2048 lds
  v_mfma_f32_16x16x32_bf16 v[172:175], a[156:159], a[192:195], v[172:175]
  ds_read_b64_tr_b16 a[152:153], v27
  v_mfma_f32_16x16x32_bf16 v[176:179], a[160:163], a[180:183], v[176:179]
  ds_read_b64_tr_b16 a[154:155], v27 offset:1024
  v_mfma_f32_16x16x32_bf16 v[180:183], a[160:163], a[184:187], v[180:183]
  ds_read_b128 a[200:203], v34 offset:5120
  v_mfma_f32_16x16x32_bf16 v[184:187], a[160:163], a[188:191], v[184:187]
  buffer_load_dwordx4 v5, s[4:7], s35 offen offset:3072 lds
  v_mfma_f32_16x16x32_bf16 v[188:191], a[160:163], a[192:195], v[188:191]
  s_waitcnt lgkmcnt(1)
  v_mfma_f32_16x16x32_bf16 v[192:195], a[148:151], a[180:183], v[192:195]
  ds_read_b64_tr_b16 a[156:157], v28
  v_mfma_f32_16x16x32_bf16 v[196:199], a[148:151], a[184:187], v[196:199]
  ds_read_b64_tr_b16 a[158:159], v28 offset:1024
  s_add_u32 m0, s33, 0x5000
  v_mfma_f32_16x16x32_bf16 v[200:203], a[148:151], a[188:191], v[200:203]
  buffer_load_dwordx4 v6, s[4:7], s35 offen lds
  v_mfma_f32_16x16x32_bf16 v[204:207], a[148:151], a[192:195], v[204:207]
  ds_read_b64_tr_b16 a[160:161], v29
  v_mfma_f32_16x16x32_bf16 v[208:211], a[152:155], a[180:183], v[208:211]
  ds_read_b64_tr_b16 a[162:163], v29 offset:1024
  v_mfma_f32_16x16x32_bf16 v[212:215], a[152:155], a[184:187], v[212:215]
  ds_read_b128 a[204:207], v34 offset:6144
  v_mfma_f32_16x16x32_bf16 v[216:219], a[152:155], a[188:191], v[216:219]
  buffer_load_dwordx4 v7, s[4:7], s35 offen offset:1024 lds
  v_mfma_f32_16x16x32_bf16 v[220:223], a[152:155], a[192:195], v[220:223]
  s_waitcnt lgkmcnt(1)
  v_mfma_f32_16x16x32_bf16 v[224:227], a[156:159], a[180:183], v[224:227]
  s_waitcnt vmcnt(6)
  ds_read_b64_tr_b16 a[148:149], v22 offset:8192
  v_mfma_f32_16x16x32_bf16 v[228:231], a[156:159], a[184:187], v[228:231]
  ds_read_b64_tr_b16 a[150:151], v22 offset:9216
  v_mfma_f32_16x16x32_bf16 v[232:235], a[156:159], a[188:191], v[232:235]
  buffer_load_dwordx4 v8, s[4:7], s35 offen offset:2048 lds
  v_mfma_f32_16x16x32_bf16 v[236:239], a[156:159], a[192:195], v[236:239]
  ds_read_b64_tr_b16 a[152:153], v23 offset:8192
  v_mfma_f32_16x16x32_bf16 v[240:243], a[160:163], a[180:183], v[240:243]
  ds_read_b64_tr_b16 a[154:155], v23 offset:9216
  v_mfma_f32_16x16x32_bf16 v[244:247], a[160:163], a[184:187], v[244:247]
  buffer_load_dwordx4 v9, s[4:7], s35 offen offset:3072 lds
  v_mfma_f32_16x16x32_bf16 v[248:251], a[160:163], a[188:191], v[248:251]
  ds_read_b128 a[208:211], v34 offset:7168
  s_add_u32 s35, s35, 0x40000
  v_mfma_f32_16x16x32_bf16 v[252:255], a[160:163], a[192:195], v[252:255]
  s_and_b32 s35, s35, 0x3fffff
  s_waitcnt lgkmcnt(0)
  v_mfma_f32_16x16x32_bf16 v[128:131], a[148:151], a[196:199], v[128:131]
  ds_read_b64_tr_b16 a[156:157], v24 offset:8192
  v_mfma_f32_16x16x32_bf16 v[132:135], a[148:151], a[200:203], v[132:135]
  ds_read_b64_tr_b16 a[158:159], v24 offset:9216
  s_add_u32 m0, s33, 0
  v_mfma_f32_16x16x32_bf16 v[136:139], a[148:151], a[204:207], v[136:139]
  buffer_load_dwordx4 v2, s[4:7], s35 offen lds
  v_mfma_f32_16x16x32_bf16 v[140:143], a[148:151], a[208:211], v[140:143]
  ds_read_b64_tr_b16 a[160:161], v25 offset:8192
  v_mfma_f32_16x16x32_bf16 v[144:147], a[152:155], a[196:199], v[144:147]
  ds_read_b64_tr_b16 a[162:163], v25 offset:9216
  v_mfma_f32_16x16x32_bf16 v[148:151], a[152:155], a[200:203], v[148:151]
  ds_read_b128 a[212:215], v34 offset:8192
  v_mfma_f32_16x16x32_bf16 v[152:155], a[152:155], a[204:207], v[152:155]
  buffer_load_dwordx4 v3, s[4:7], s35 offen offset:1024 lds
  v_mfma_f32_16x16x32_bf16 v[156:159], a[152:155], a[208:211], v[156:159]
  s_waitcnt lgkmcnt(1)
  v_mfma_f32_16x16x32_bf16 v[160:163], a[156:159], a[196:199], v[160:163]
  ds_read_b64_tr_b16 a[148:149], v26 offset:8192
  v_mfma_f32_16x16x32_bf16 v[164:167], a[156:159], a[200:203], v[164:167]
  ds_read_b64_tr_b16 a[150:151], v26 offset:9216
  v_mfma_f32_16x16x32_bf16 v[168:171], a[156:159], a[204:207], v[168:171]
  buffer_load_dwordx4 v4, s[4:7], s35 offen offset:2048 lds
  v_mfma_f32_16x16x32_bf16 v[172:175], a[156:159], a[208:211], v[172:175]
  ds_read_b64_tr_b16 a[152:153], v27 offset:8192
  v_mfma_f32_16x16x32_bf16 v[176:179], a[160:163], a[196:199], v[176:179]
  ds_read_b64_tr_b16 a[154:155], v27 offset:9216
  v_mfma_f32_16x16x32_bf16 v[180:183], a[160:163], a[200:203], v[180:183]
  ds_read_b128 a[216:219], v34 offset:9216
  v_mfma_f32_16x16x32_bf16 v[184:187], a[160:163], a[204:207], v[184:187]
  buffer_load_dwordx4 v5, s[4:7], s35 offen offset:3072 lds
  v_mfma_f32_16x16x32_bf16 v[188:191], a[160:163], a[208:211], v[188:191]
  s_waitcnt lgkmcnt(1)
  v_mfma_f32_16x16x32_bf16 v[192:195], a[148:151], a[196:199], v[192:195]
  ds_read_b64_tr_b16 a[156:157], v28 offset:8192
  v_mfma_f32_16x16x32_bf16 v[196:199], a[148:151], a[200:203], v[196:199]
  ds_read_b64_tr_b16 a[158:159], v28 offset:9216
  s_add_u32 m0, s33, 0x1000
  v_mfma_f32_16x16x32_bf16 v[200:203], a[148:151], a[204:207], v[200:203]
  buffer_load_dwordx4 v6, s[4:7], s35 offen lds
  v_mfma_f32_16x16x32_bf16 v[204:207], a[148:151], a[208:211], v[204:207]
  ds_read_b64_tr_b16 a[160:161], v29 offset:8192
  v_mfma_f32_16x16x32_bf16 v[208:211], a[152:155], a[196:199], v[208:211]
  ds_read_b64_tr_b16 a[162:163], v29 offset:9216
  v_mfma_f32_16x16x32_bf16 v[212:215], a[152:155], a[200:203], v[212:215]
  ds_read_b128 a[220:223], v34 offset:10240
  v_mfma_f32_16x16x32_bf16 v[216:219], a[152:155], a[204:207], v[216:219]
  buffer_load_dwordx4 v7, s[4:7], s35 offen offset:1024 lds
  v_mfma_f32_16x16x32_bf16 v[220:223], a[152:155], a[208:211], v[220:223]
  s_waitcnt lgkmcnt(1)
  v_mfma_f32_16x16x32_bf16 v[224:227], a[156:159], a[196:199], v[224:227]
  s_waitcnt vmcnt(6)
  ds_read_b64_tr_b16 a[148:149], v22 offset:16384
  v_mfma_f32_16x16x32_bf16 v[228:231], a[156:159], a[200:203], v[228:231]
  ds_read_b64_tr_b16 a[150:151], v22 offset:17408
  v_mfma_f32_16x16x32_bf16 v[232:235], a[156:159], a[204:207], v[232:235]
  buffer_load_dwordx4 v8, s[4:7], s35 offen offset:2048 lds
  v_mfma_f32_16x16x32_bf16 v[236:239], a[156:159], a[208:211], v[236:239]
  ds_read_b64_tr_b16 a[152:153], v23 offset:16384
  v_mfma_f32_16x16x32_bf16 v[240:243], a[160:163], a[196:199], v[240:243]
  ds_read_b64_tr_b16 a[154:155], v23 offset:17408
  v_mfma_f32_16x16x32_bf16 v[244:247], a[160:163], a[200:203], v[244:247]
  buffer_load_dwordx4 v9, s[4:7], s35 offen offset:3072 lds
  v_mfma_f32_16x16x32_bf16 v[248:251], a[160:163], a[204:207], v[248:251]
  ds_read_b128 a[224:227], v34 offset:11264
  s_add_u32 s35, s35, 0x40000
  v_mfma_f32_16x16x32_bf16 v[252:255], a[160:163], a[208:211], v[252:255]
  s_and_b32 s35, s35, 0x3fffff
  s_waitcnt lgkmcnt(0)
  v_mfma_f32_16x16x32_bf16 v[128:131], a[148:151], a[212:215], v[128:131]
  ds_read_b64_tr_b16 a[156:157], v24 offset:16384
  v_mfma_f32_16x16x32_bf16 v[132:135], a[148:151], a[216:219], v[132:135]
  ds_read_b64_tr_b16 a[158:159], v24 offset:17408
  s_add_u32 m0, s33, 0x2000
  v_mfma_f32_16x16x32_bf16 v[136:139], a[148:151], a[220:223], v[136:139]
  buffer_load_dwordx4 v2, s[4:7], s35 offen lds
  v_mfma_f32_16x16x32_bf16 v[140:143], a[148:151], a[224:227], v[140:143]
  ds_read_b64_tr_b16 a[160:161], v25 offset:16384
  v_mfma_f32_16x16x32_bf16 v[144:147], a[152:155], a[212:215], v[144:147]
  ds_read_b64_tr_b16 a[162:163], v25 offset:17408
  v_mfma_f32_16x16x32_bf16 v[148:151], a[152:155], a[216:219], v[148:151]
  ds_read_b128 a[180:183], v34 offset:12288
  v_mfma_f32_16x16x32_bf16 v[152:155], a[152:155], a[220:223], v[152:155]
  buffer_load_dwordx4 v3, s[4:7], s35 offen offset:1024 lds
  v_mfma_f32_16x16x32_bf16 v[156:159], a[152:155], a[224:227], v[156:159]
  s_waitcnt lgkmcnt(1)
  v_mfma_f32_16x16x32_bf16 v[160:163], a[156:159], a[212:215], v[160:163]
  ds_read_b64_tr_b16 a[148:149], v26 offset:16384
  v_mfma_f32_16x16x32_bf16 v[164:167], a[156:159], a[216:219], v[164:167]
  ds_read_b64_tr_b16 a[150:151], v26 offset:17408
  v_mfma_f32_16x16x32_bf16 v[168:171], a[156:159], a[220:223], v[168:171]
  buffer_load_dwordx4 v4, s[4:7], s35 offen offset:2048 lds
  v_mfma_f32_16x16x32_bf16 v[172:175], a[156:159], a[224:227], v[172:175]
  ds_read_b64_tr_b16 a[152:153], v27 offset:16384
  v_mfma_f32_16x16x32_bf16 v[176:179], a[160:163], a[212:215], v[176:179]
  ds_read_b64_tr_b16 a[154:155], v27 offset:17408
  v_mfma_f32_16x16x32_bf16 v[180:183], a[160:163], a[216:219], v[180:183]
  ds_read_b128 a[184:187], v34 offset:13312
  v_mfma_f32_16x16x32_bf16 v[184:187], a[160:163], a[220:223], v[184:187]
  buffer_load_dwordx4 v5, s[4:7], s35 offen offset:3072 lds
  v_mfma_f32_16x16x32_bf16 v[188:191], a[160:163], a[224:227], v[188:191]
  s_waitcnt lgkmcnt(1)
  v_mfma_f32_16x16x32_bf16 v[192:195], a[148:151], a[212:215], v[192:195]
  ds_read_b64_tr_b16 a[156:157], v28 offset:16384
  v_mfma_f32_16x16x32_bf16 v[196:199], a[148:151], a[216:219], v[196:199]
  ds_read_b64_tr_b16 a[158:159], v28 offset:17408
  s_add_u32 m0, s33, 0x3000
  v_mfma_f32_16x16x32_bf16 v[200:203], a[148:151], a[220:223], v[200:203]
  buffer_load_dwordx4 v6, s[4:7], s35 offen lds
  v_mfma_f32_16x16x32_bf16 v[204:207], a[148:151], a[224:227], v[204:207]
  ds_read_b64_tr_b16 a[160:161], v29 offset:16384
  v_mfma_f32_16x16x32_bf16 v[208:211], a[152:155], a[212:215], v[208:211]
  ds_read_b64_tr_b16 a[162:163], v29 offset:17408
  v_mfma_f32_16x16x32_bf16 v[212:215], a[152:155], a[216:219], v[212:215]
  ds_read_b128 a[188:191], v34 offset:14336
  v_mfma_f32_16x16x32_bf16 v[216:219], a[152:155], a[220:223], v[216:219]
  buffer_load_dwordx4 v7, s[4:7], s35 offen offset:1024 lds
  v_mfma_f32_16x16x32_bf16 v[220:223], a[152:155], a[224:227], v[220:223]
  s_waitcnt lgkmcnt(1)
  v_mfma_f32_16x16x32_bf16 v[224:227], a[156:159], a[212:215], v[224:227]
  s_waitcnt vmcnt(6)
  ds_read_b64_tr_b16 a[148:149], v22
  v_mfma_f32_16x16x32_bf16 v[228:231], a[156:159], a[216:219], v[228:231]
  ds_read_b64_tr_b16 a[150:151], v22 offset:1024
  v_mfma_f32_16x16x32_bf16 v[232:235], a[156:159], a[220:223], v[232:235]
  buffer_load_dwordx4 v8, s[4:7], s35 offen offset:2048 lds
  v_mfma_f32_16x16x32_bf16 v[236:239], a[156:159], a[224:227], v[236:239]
  ds_read_b64_tr_b16 a[152:153], v23
  v_mfma_f32_16x16x32_bf16 v[240:243], a[160:163], a[212:215], v[240:243]
  ds_read_b64_tr_b16 a[154:155], v23 offset:1024
  v_mfma_f32_16x16x32_bf16 v[244:247], a[160:163], a[216:219], v[244:247]
  buffer_load_dwordx4 v9, s[4:7], s35 offen offset:3072 lds
  v_mfma_f32_16x16x32_bf16 v[248:251], a[160:163], a[220:223], v[248:251]
  ds_read_b128 a[192:195], v34 offset:15360
  s_add_u32 s35, s35, 0x40000
  v_mfma_f32_16x16x32_bf16 v[252:255], a[160:163], a[224:227], v[252:255]
  s_and_b32 s35, s35, 0x3fffff
  v_add_u32 v34, 0x3000, v34
  s_sub_u32 s38, s38, 1
  s_cmp_lg_u32 s38, 0
  s_cbranch_scc1 L_gq_1
  s_waitcnt lgkmcnt(0)
  v_mfma_f32_16x16x32_bf16 v[128:131], a[148:151], a[180:183], v[128:131]
  ds_read_b64_tr_b16 a[156:157], v24
  v_mfma_f32_16x16x32_bf16 v[132:135], a[148:151], a[184:187], v[132:135]
  ds_read_b64_tr_b16 a[158:159], v24 offset:1024
  s_add_u32 m0, s33, 0x4000
  v_mfma_f32_16x16x32_bf16 v[136:139], a[148:151], a[188:191], v[136:139]
  buffer_load_dwordx4 v2, s[4:7], s35 offen lds
  v_mfma_f32_16x16x32_bf16 v[140:143], a[148:151], a[192:195], v[140:143]
  ds_read_b64_tr_b16 a[160:161], v25
  v_mfma_f32_16x16x32_bf16 v[144:147], a[152:155], a[180:183], v[144:147]
  ds_read_b64_tr_b16 a[162:163], v25 offset:1024
  v_mfma_f32_16x16x32_bf16 v[148:151], a[152:155], a[184:187], v[148:151]
  ds_read_b128 a[196:199], v34 offset:4096
  v_mfma_f32_16x16x32_bf16 v[152:155], a[152:155], a[188:191], v[152:155]
  buffer_load_dwordx4 v3, s[4:7], s35 offen offset:1024 lds
  v_mfma_f32_16x16x32_bf16 v[156:159], a[152:155], a[192:195], v[156:159]
  s_waitcnt lgkmcnt(1)
  v_mfma_f32_16x16x32_bf16 v[160:163], a[156:159], a[180:183], v[160:163]
  ds_read_b64_tr_b16 a[148:149], v26
  v_mfma_f32_16x16x32_bf16 v[164:167], a[156:159], a[184:187], v[164:167]
  ds_read_b64_tr_b16 a[150:151], v26 offset:1024
  v_mfma_f32_16x16x32_bf16 v[168:171], a[156:159], a[188:191], v[168:171]
  buffer_load_dwordx4 v4, s[4:7], s35 offen offset:2048 lds
  v_mfma_f32_16x16x32_bf16 v[172:175], a[156:159], a[192:195], v[172:175]
  ds_read_b64_tr_b16 a[152:153], v27
  v_mfma_f32_16x16x32_bf16 v[176:179], a[160:163], a[180:183], v[176:179]
  ds_read_b64_tr_b16 a[154:155], v27 offset:1024
  v_mfma_f32_16x16x32_bf16 v[180:183], a[160:163], a[184:187], v[180:183]
  ds_read_b128 a[200:203], v34 offset:5120
  v_mfma_f32_16x16x32_bf16 v[184:187], a[160:163], a[188:191], v[184:187]
  buffer_load_dwordx4 v5, s[4:7], s35 offen offset:3072 lds
  v_mfma_f32_16x16x32_bf16 v[188:191], a[160:163], a[192:195], v[188:191]
  s_waitcnt lgkmcnt(1)
  v_mfma_f32_16x16x32_bf16 v[192:195], a[148:151], a[180:183], v[192:195]
  ds_read_b64_tr_b16 a[156:157], v28
  v_mfma_f32_16x16x32_bf16 v[196:199], a[148:151], a[184:187], v[196:199]
  ds_read_b64_tr_b16 a[158:159], v28 offset:1024
  s_add_u32 m0, s33, 0x5000
  v_mfma_f32_16x16x32_bf16 v[200:203], a[148:151], a[188:191], v[200:203]
  buffer_load_dwordx4 v6, s[4:7], s35 offen lds
  v_mfma_f32_16x16x32_bf16 v[204:207], a[148:151], a[192:195], v[204:207]
  ds_read_b64_tr_b16 a[160:161], v29
  v_mfma_f32_16x16x32_bf16 v[208:211], a[152:155], a[180:183], v[208:211]
  ds_read_b64_tr_b16 a[162:163], v29 offset:1024
  v_mfma_f32_16x16x32_bf16 v[212:215], a[152:155], a[184:187], v[212:215]
  ds_read_b128 a[204:207], v34 offset:6144
  v_mfma_f32_16x16x32_bf16 v[216:219], a[152:155], a[188:191], v[216:219]
  buffer_load_dwordx4 v7, s[4:7], s35 offen offset:1024 lds
  v_mfma_f32_16x16x32_bf16 v[220:223], a[152:155], a[192:195], v[220:223]
  s_waitcnt lgkmcnt(1)
  v_mfma_f32_16x16x32_bf16 v[224:227], a[156:159], a[180:183], v[224:227]
  s_waitcnt vmcnt(6)
  ds_read_b64_tr_b16 a[148:149], v22 offset:8192
  v_mfma_f32_16x16x32_bf16 v[228:231], a[156:159], a[184:187], v[228:231]
  ds_read_b64_tr_b16 a[150:151], v22 offset:9216
  v_mfma_f32_16x16x32_bf16 v[232:235], a[156:159], a[188:191], v[232:235]
  buffer_load_dwordx4 v8, s[4:7], s35 offen offset:2048 lds
  v_mfma_f32_16x16x32_bf16 v[236:239], a[156:159], a[192:195], v[236:239]
  ds_read_b64_tr_b16 a[152:153], v23 offset:8192
  v_mfma_f32_16x16x32_bf16 v[240:243], a[160:163], a[180:183], v[240:243]
  ds_read_b64_tr_b16 a[154:155], v23 offset:9216
  v_mfma_f32_16x16x32_bf16 v[244:247], a[160:163], a[184:187], v[244:247]
  buffer_load_dwordx4 v9, s[4:7], s35 offen offset:3072 lds
  v_mfma_f32_16x16x32_bf16 v[248:251], a[160:163], a[188:191], v[248:251]
  ds_read_b128 a[208:211], v34 offset:7168
  s_add_u32 s35, s35, 0x40000
  v_mfma_f32_16x16x32_bf16 v[252:255], a[160:163], a[192:195], v[252:255]
  s_and_b32 s35, s35, 0x3fffff
  s_waitcnt lgkmcnt(0)
  v_mfma_f32_16x16x32_bf16 v[128:131], a[148:151], a[196:199], v[128:131]
  ds_read_b64_tr_b16 a[156:157], v24 offset:8192
  v_mfma_f32_16x16x32_bf16 v[132:135], a[148:151], a[200:203], v[132:135]
  ds_read_b64_tr_b16 a[158:159], v24 offset:9216
  s_add_u32 m0, s33, 0
  v_mfma_f32_16x16x32_bf16 v[136:139], a[148:151], a[204:207], v[136:139]
  buffer_load_dwordx4 v2, s[4:7], s35 offen lds
  v_mfma_f32_16x16x32_bf16 v[140:143], a[148:151], a[208:211], v[140:143]
  ds_read_b64_tr_b16 a[160:161], v25 offset:8192
  v_mfma_f32_16x16x32_bf16 v[144:147], a[152:155], a[196:199], v[144:147]
  ds_read_b64_tr_b16 a[162:163], v25 offset:9216
  v_mfma_f32_16x16x32_bf16 v[148:151], a[152:155], a[200:203], v[148:151]
  ds_read_b128 a[212:215], v34 offset:8192
  v_mfma_f32_16x16x32_bf16 v[152:155], a[152:155], a[204:207], v[152:155]
  buffer_load_dwordx4 v3, s[4:7], s35 offen offset:1024 lds
  v_mfma_f32_16x16x32_bf16 v[156:159], a[152:155], a[208:211], v[156:159]
  s_waitcnt lgkmcnt(1)
  v_mfma_f32_16x16x32_bf16 v[160:163], a[156:159], a[196:199], v[160:163]
  ds_read_b64_tr_b16 a[148:149], v26 offset:8192
  v_mfma_f32_16x16x32_bf16 v[164:167], a[156:159], a[200:203], v[164:167]
  ds_read_b64_tr_b16 a[150:151], v26 offset:9216
  v_mfma_f32_16x16x32_bf16 v[168:171], a[156:159], a[204:207], v[168:171]
  buffer_load_dwordx4 v4, s[4:7], s35 offen offset:2048 lds
  v_mfma_f32_16x16x32_bf16 v[172:175], a[156:159], a[208:211], v[172:175]
  ds_read_b64_tr_b16 a[152:153], v27 offset:8192
  v_mfma_f32_16x16x32_bf16 v[176:179], a[160:163], a[196:199], v[176:179]
  ds_read_b64_tr_b16 a[154:155], v27 offset:9216
  v_mfma_f32_16x16x32_bf16 v[180:183], a[160:163], a[200:203], v[180:183]
  ds_read_b128 a[216:219], v34 offset:9216
  v_mfma_f32_16x16x32_bf16 v[184:187], a[160:163], a[204:207], v[184:187]
  buffer_load_dwordx4 v5, s[4:7], s35 offen offset:3072 lds
  v_mfma_f32_16x16x32_bf16 v[188:191], a[160:163], a[208:211], v[188:191]
  s_waitcnt lgkmcnt(1)
  v_mfma_f32_16x16x32_bf16 v[192:195], a[148:151], a[196:199], v[192:195]
  ds_read_b64_tr_b16 a[156:157], v28 offset:8192
  v_mfma_f32_16x16x32_bf16 v[196:199], a[148:151], a[200:203], v[196:199]
  ds_read_b64_tr_b16 a[158:159], v28 offset:9216
  s_add_u32 m0, s33, 0x1000
  v_mfma_f32_16x16x32_bf16 v[200:203], a[148:151], a[204:207], v[200:203]
  buffer_load_dwordx4 v6, s[4:7], s35 offen lds
  v_mfma_f32_16x16x32_bf16 v[204:207], a[148:151], a[208:211], v[204:207]
  ds_read_b64_tr_b16 a[160:161], v29 offset:8192
  v_mfma_f32_16x16x32_bf16 v[208:211], a[152:155], a[196:199], v[208:211]
  ds_read_b64_tr_b16 a[162:163], v29 offset:9216
  v_mfma_f32_16x16x32_bf16 v[212:215], a[152:155], a[200:203], v[212:215]
  ds_read_b128 a[220:223], v34 offset:10240
  v_mfma_f32_16x16x32_bf16 v[216:219], a[152:155], a[204:207], v[216:219]
  buffer_load_dwordx4 v7, s[4:7], s35 offen offset:1024 lds
  v_mfma_f32_16x16x32_bf16 v[220:223], a[152:155], a[208:211], v[220:223]
  s_waitcnt lgkmcnt(1)
  v_mfma_f32_16x16x32_bf16 v[224:227], a[156:159], a[196:199], v[224:227]
  s_waitcnt vmcnt(6)
  ds_read_b64_tr_b16 a[148:149], v22 offset:16384
  v_mfma_f32_16x16x32_bf16 v[228:231], a[156:159], a[200:203], v[228:231]
  ds_read_b64_tr_b16 a[150:151], v22 offset:17408
  v_mfma_f32_16x16x32_bf16 v[232:235], a[156:159], a[204:207], v[232:235]
  buffer_load_dwordx4 v8, s[4:7], s35 offen offset:2048 lds
  v_mfma_f32_16x16x32_bf16 v[236:239], a[156:159], a[208:211], v[236:239]
  ds_read_b64_tr_b16 a[152:153], v23 offset:16384
  v_mfma_f32_16x16x32_bf16 v[240:243], a[160:163], a[196:199], v[240:243]
  ds_read_b64_tr_b16 a[154:155], v23 offset:17408
  v_mfma_f32_16x16x32_bf16 v[244:247], a[160:163], a[200:203], v[244:247]
  buffer_load_dwordx4 v9, s[4:7], s35 offen offset:3072 lds
  v_mfma_f32_16x16x32_bf16 v[248:251], a[160:163], a[204:207], v[248:251]
  ds_read_b128 a[224:227], v34 offset:11264
  s_add_u32 s35, s35, 0x40000
  v_mfma_f32_16x16x32_bf16 v[252:255], a[160:163], a[208:211], v[252:255]
  s_and_b32 s35, s35, 0x3fffff
  s_waitcnt lgkmcnt(0)
  v_mfma_f32_16x16x32_bf16 v[128:131], a[148:151], a[212:215], v[128:131]
  ds_read_b64_tr_b16 a[156:157], v24 offset:16384
  v_mfma_f32_16x16x32_bf16 v[132:135], a[148:151], a[216:219], v[132:135]
  ds_read_b64_tr_b16 a[158:159], v24 offset:17408
  s_add_u32 m0, s33, 0x2000
  v_mfma_f32_16x16x32_bf16 v[136:139], a[148:151], a[220:223], v[136:139]
  buffer_load_dwordx4 v10, s[8:11], s36 offen lds
  v_mfma_f32_16x16x32_bf16 v[140:143], a[148:151], a[224:227], v[140:143]
  ds_read_b64_tr_b16 a[160:161], v25 offset:16384
  v_mfma_f32_16x16x32_bf16 v[144:147], a[152:155], a[212:215], v[144:147]
  ds_read_b64_tr_b16 a[162:163], v25 offset:17408
  v_mfma_f32_16x16x32_bf16 v[148:151], a[152:155], a[216:219], v[148:151]
  ds_read_b128 a[180:183], v34 offset:12288
  v_mfma_f32_16x16x32_bf16 v[152:155], a[152:155], a[220:223], v[152:155]
  buffer_load_dwordx4 v11, s[8:11], s36 offen offset:1024 lds
  v_mfma_f32_16x16x32_bf16 v[156:159], a[152:155], a[224:227], v[156:159]
  s_waitcnt lgkmcnt(1)
  v_mfma_f32_16x16x32_bf16 v[160:163], a[156:159], a[212:215], v[160:163]
  ds_read_b64_tr_b16 a[148:149], v26 offset:16384
  v_mfma_f32_16x16x32_bf16 v[164:167], a[156:159], a[216:219], v[164:167]
  ds_read_b64_tr_b16 a[150:151], v26 offset:17408
  v_mfma_f32_16x16x32_bf16 v[168:171], a[156:159], a[220:223], v[168:171]
  buffer_load_dwordx4 v12, s[8:11], s36 offen offset:2048 lds
  v_mfma_f32_16x16x32_bf16 v[172:175], a[156:159], a[224:227], v[172:175]
  ds_read_b64_tr_b16 a[152:153], v27 offset:16384
  v_mfma_f32_16x16x32_bf16 v[176:179], a[160:163], a[212:215], v[176:179]
  ds_read_b64_tr_b16 a[154:155], v27 offset:17408
  v_mfma_f32_16x16x32_bf16 v[180:183], a[160:163], a[216:219], v[180:183]
  ds_read_b128 a[184:187], v34 offset:13312
  v_mfma_f32_16x16x32_bf16 v[184:187], a[160:163], a[220:223], v[184:187]
  buffer_load_dwordx4 v13, s[8:11], s36 offen offset:3072 lds
  v_mfma_f32_16x16x32_bf16 v[188:191], a[160:163], a[224:227], v[188:191]
  s_waitcnt lgkmcnt(1)
  v_mfma_f32_16x16x32_bf16 v[192:195], a[148:151], a[212:215], v[192:195]
  ds_read_b64_tr_b16 a[156:157], v28 offset:16384
  v_mfma_f32_16x16x32_bf16 v[196:199], a[148:151], a[216:219], v[196:199]
  ds_read_b64_tr_b16 a[158:159], v28 offset:17408
  s_add_u32 m0, s33, 0x3000
  v_mfma_f32_16x16x32_bf16 v[200:203], a[148:151], a[220:223], v[200:203]
  buffer_load_dwordx4 v14, s[8:11], s36 offen lds
  v_mfma_f32_16x16x32_bf16 v[204:207], a[148:151], a[224:227], v[204:207]
  ds_read_b64_tr_b16 a[160:161], v29 offset:16384
  v_mfma_f32_16x16x32_bf16 v[208:211], a[152:155], a[212:215], v[208:211]
  ds_read_b64_tr_b16 a[162:163], v29 offset:17408
  v_mfma_f32_16x16x32_bf16 v[212:215], a[152:155], a[216:219], v[212:215]
  ds_read_b128 a[188:191], v34 offset:14336
  v_mfma_f32_16x16x32_bf16 v[216:219], a[152:155], a[220:223], v[216:219]
  buffer_load_dwordx4 v15, s[8:11], s36 offen offset:1024 lds
  v_mfma_f32_16x16x32_bf16 v[220:223], a[152:155], a[224:227], v[220:223]
  s_waitcnt lgkmcnt(1)
  v_mfma_f32_16x16x32_bf16 v[224:227], a[156:159], a[212:215], v[224:227]
  s_waitcnt vmcnt(6)
  ds_read_b64_tr_b16 a[148:149], v22
  v_mfma_f32_16x16x32_bf16 v[228:231], a[156:159], a[216:219], v[228:231]
  ds_read_b64_tr_b16 a[150:151], v22 offset:1024
  v_mfma_f32_16x16x32_bf16 v[232:235], a[156:159], a[220:223], v[232:235]
  buffer_load_dwordx4 v16, s[8:11], s36 offen offset:2048 lds
  v_mfma_f32_16x16x32_bf16 v[236:239], a[156:159], a[224:227], v[236:239]
  ds_read_b64_tr_b16 a[152:153], v23
  v_mfma_f32_16x16x32_bf16 v[240:243], a[160:163], a[212:215], v[240:243]
  ds_read_b64_tr_b16 a[154:155], v23 offset:1024
  v_mfma_f32_16x16x32_bf16 v[244:247], a[160:163], a[216:219], v[244:247]
  buffer_load_dwordx4 v17, s[8:11], s36 offen offset:3072 lds
  v_mfma_f32_16x16x32_bf16 v[248:251], a[160:163], a[220:223], v[248:251]
  ds_read_b128 a[192:195], v34 offset:15360
  s_add_u32 s36, s36, 0x2000
  v_mfma_f32_16x16x32_bf16 v[252:255], a[160:163], a[224:227], v[252:255]
  s_and_b32 s36, s36, 0x1ffff
  v_add_u32 v34, 0x3000, v34
  s_nop 0
  s_nop 0
  s_nop 0
  s_waitcnt lgkmcnt(0)
  v_mfma_f32_16x16x32_bf16 v[128:131], a[148:151], a[180:183], v[128:131]
  ds_read_b64_tr_b16 a[156:157], v24
  v_lshrrev_b32 v36, 4, v1
  v_and_b32 v37, 15, v1
  v_mfma_f32_16x16x32_bf16 v[132:135], a[148:151], a[184:187], v[132:135]
  ds_read_b64_tr_b16 a[158:159], v24 offset:1024
  s_add_u32 m0, s33, 0x4000
  s_mov_b32 s39, 0x400
  v_mfma_f32_16x16x32_bf16 v[136:139], a[148:151], a[188:191], v[136:139]
  buffer_load_dwordx4 v10, s[8:11], s36 offen lds
  v_mul_lo_u32 v38, v36, s39
  v_add_u32 v39, 0, v36
  v_mfma_f32_16x16x32_bf16 v[140:143], a[148:151], a[192:195], v[140:143]
  ds_read_b64_tr_b16 a[160:161], v25
  s_barrier
  v_lshlrev_b32 v39, 1, v39
  v_mfma_f32_16x16x32_bf16 v[144:147], a[152:155], a[180:183], v[144:147]
  ds_read_b64_tr_b16 a[162:163], v25 offset:1024
  v_xor_b32 v39, v39, v37
  v_lshlrev_b32 v39, 4, v39
  v_mfma_f32_16x16x32_bf16 v[148:151], a[152:155], a[184:187], v[148:151]
  v_add_u32 v40, v39, v38
  v_add_u32 v39, 4, v36
  v_lshlrev_b32 v39, 1, v39
  v_mfma_f32_16x16x32_bf16 v[152:155], a[152:155], a[188:191], v[152:155]
  buffer_load_dwordx4 v11, s[8:11], s36 offen offset:1024 lds
  v_xor_b32 v39, v39, v37
  v_lshlrev_b32 v39, 4, v39
  v_mfma_f32_16x16x32_bf16 v[156:159], a[152:155], a[192:195], v[156:159]
  v_add_u32 v41, v39, v38
  v_mov_b32 v2, v40
  v_add_u32 v3, 0xc00, v41
  s_waitcnt lgkmcnt(0)
  v_mfma_f32_16x16x32_bf16 v[160:163], a[156:159], a[180:183], v[160:163]
  ds_read_b64_tr_b16 a[148:149], v26
  v_add_u32 v4, 0x1800, v40
  v_add_u32 v5, 0x2400, v41
  v_mfma_f32_16x16x32_bf16 v[164:167], a[156:159], a[184:187], v[164:167]
  ds_read_b64_tr_b16 a[150:151], v26 offset:1024
  v_add_u32 v6, 0x4000, v40
  v_add_u32 v7, 0x4c00, v41
  v_mfma_f32_16x16x32_bf16 v[168:171], a[156:159], a[188:191], v[168:171]
  buffer_load_dwordx4 v12, s[8:11], s36 offen offset:2048 lds
  v_add_u32 v8, 0x5800, v40
  v_add_u32 v9, 0x6400, v41
  v_mfma_f32_16x16x32_bf16 v[172:175], a[156:159], a[192:195], v[172:175]
  ds_read_b64_tr_b16 a[152:153], v27
  v_cvt_pk_bf16_f32 v64, v128, v129
  v_cvt_pk_bf16_f32 v65, v130, v131
  v_mfma_f32_16x16x32_bf16 v[176:179], a[160:163], a[180:183], v[176:179]
  ds_read_b64_tr_b16 a[154:155], v27 offset:1024
  v_cvt_pk_bf16_f32 v66, v144, v145
  v_cvt_pk_bf16_f32 v67, v146, v147
  v_mfma_f32_16x16x32_bf16 v[180:183], a[160:163], a[184:187], v[180:183]
  v_cvt_pk_bf16_f32 v80, v132, v133
  v_cvt_pk_bf16_f32 v81, v134, v135
  v_cvt_pk_bf16_f32 v82, v148, v149
  v_mfma_f32_16x16x32_bf16 v[184:187], a[160:163], a[188:191], v[184:187]
  buffer_load_dwordx4 v13, s[8:11], s36 offen offset:3072 lds
  v_cvt_pk_bf16_f32 v83, v150, v151
  v_cvt_pk_bf16_f32 v96, v136, v137
  v_mfma_f32_16x16x32_bf16 v[188:191], a[160:163], a[192:195], v[188:191]
  v_cvt_pk_bf16_f32 v97, v138, v139
  v_cvt_pk_bf16_f32 v98, v152, v153
  v_cvt_pk_bf16_f32 v99, v154, v155
  s_waitcnt lgkmcnt(0)
  v_mfma_f32_16x16x32_bf16 v[192:195], a[148:151], a[180:183], v[192:195]
  ds_read_b64_tr_b16 a[156:157], v28
  v_cvt_pk_bf16_f32 v112, v140, v141
  v_cvt_pk_bf16_f32 v113, v142, v143
  v_mfma_f32_16x16x32_bf16 v[196:199], a[148:151], a[184:187], v[196:199]
  ds_read_b64_tr_b16 a[158:159], v28 offset:1024
  s_add_u32 m0, s33, 0x5000
  v_cvt_pk_bf16_f32 v114, v156, v157
  v_mfma_f32_16x16x32_bf16 v[200:203], a[148:151], a[188:191], v[200:203]
  buffer_load_dwordx4 v14, s[8:11], s36 offen lds
  v_cvt_pk_bf16_f32 v115, v158, v159
  v_cvt_pk_bf16_f32 v68, v160, v161
  v_mfma_f32_16x16x32_bf16 v[204:207], a[148:151], a[192:195], v[204:207]
  ds_read_b64_tr_b16 a[160:161], v29
  v_cvt_pk_bf16_f32 v69, v162, v163
  v_cvt_pk_bf16_f32 v70, v176, v177
  v_mfma_f32_16x16x32_bf16 v[208:211], a[152:155], a[180:183], v[208:211]
  ds_read_b64_tr_b16 a[162:163], v29 offset:1024
  v_cvt_pk_bf16_f32 v71, v178, v179
  v_cvt_pk_bf16_f32 v84, v164, v165
  v_mfma_f32_16x16x32_bf16 v[212:215], a[152:155], a[184:187], v[212:215]
  v_cvt_pk_bf16_f32 v85, v166, v167
  v_cvt_pk_bf16_f32 v86, v180, v181
  v_cvt_pk_bf16_f32 v87, v182, v183
  v_mfma_f32_16x16x32_bf16 v[216:219], a[152:155], a[188:191], v[216:219]
  buffer_load_dwordx4 v15, s[8:11], s36 offen offset:1024 lds
  v_cvt_pk_bf16_f32 v100, v168, v169
  v_cvt_pk_bf16_f32 v101, v170, v171
  v_mfma_f32_16x16x32_bf16 v[220:223], a[152:155], a[192:195], v[220:223]
  v_cvt_pk_bf16_f32 v102, v184, v185
  v_cvt_pk_bf16_f32 v103, v186, v187
  v_cvt_pk_bf16_f32 v116, v172, v173
  s_waitcnt lgkmcnt(0)
  v_mfma_f32_16x16x32_bf16 v[224:227], a[156:159], a[180:183], v[224:227]
  v_cvt_pk_bf16_f32 v117, v174, v175
  v_cvt_pk_bf16_f32 v118, v188, v189
  v_cvt_pk_bf16_f32 v119, v190, v191
  v_mfma_f32_16x16x32_bf16 v[228:231], a[156:159], a[184:187], v[228:231]
  v_mfma_f32_16x16x32_bf16 v[232:235], a[156:159], a[188:191], v[232:235]
  buffer_load_dwordx4 v16, s[8:11], s36 offen offset:2048 lds
  v_cvt_pk_bf16_f32 v72, v192, v193
  v_cvt_pk_bf16_f32 v73, v194, v195
  v_cvt_pk_bf16_f32 v74, v208, v209
  v_mfma_f32_16x16x32_bf16 v[236:239], a[156:159], a[192:195], v[236:239]
  v_cvt_pk_bf16_f32 v75, v210, v211
  v_cvt_pk_bf16_f32 v88, v196, v197
  v_cvt_pk_bf16_f32 v89, v198, v199
  v_cvt_pk_bf16_f32 v90, v212, v213
  v_mfma_f32_16x16x32_bf16 v[240:243], a[160:163], a[180:183], v[240:243]
  v_cvt_pk_bf16_f32 v91, v214, v215
  v_cvt_pk_bf16_f32 v104, v200, v201
  v_cvt_pk_bf16_f32 v105, v202, v203
  v_mfma_f32_16x16x32_bf16 v[244:247], a[160:163], a[184:187], v[244:247]
  buffer_load_dwordx4 v17, s[8:11], s36 offen offset:3072 lds
  v_cvt_pk_bf16_f32 v106, v216, v217
  v_cvt_pk_bf16_f32 v107, v218, v219
  v_mfma_f32_16x16x32_bf16 v[248:251], a[160:163], a[188:191], v[248:251]
  s_add_u32 s36, s36, 0x2000
  v_cvt_pk_bf16_f32 v120, v204, v205
  v_cvt_pk_bf16_f32 v121, v206, v207
  v_mfma_f32_16x16x32_bf16 v[252:255], a[160:163], a[192:195], v[252:255]
  s_and_b32 s36, s36, 0x1ffff
  v_cvt_pk_bf16_f32 v122, v220, v221
  v_cvt_pk_bf16_f32 v123, v222, v223
  s_nop 0
  s_nop 0
  s_nop 0
  v_subrev_u32 v34, 0xf000, v34
  s_cmp_lg_u32 s28, 3
  s_cbranch_scc1 M_late_done
  v_mov_b32 v62, s90
  v_mov_b32 v63, 0
  s_lshl_b32 s50, s2, 7
  s_add_u32 s50, s50, 0x2018000
  s_mov_b64 exec, 1
  buffer_store_dword v62, v63, s[20:23], s50 offen sc1
  s_mov_b64 exec, -1
  s_sub_u32 s44, s71, 32
  s_cmp_ge_u32 s44, 64
  s_cbranch_scc1 M_late_done
  s_waitcnt vmcnt(0)
  v_mov_b32 v62, 1
  v_mov_b32 v63, 0
  s_mov_b64 exec, 1
  buffer_atomic_add v62, v63, s[96:99], 0 offen offset:8 sc1
  s_mov_b64 exec, -1
M_late_done:
  s_add_u32 m0, s34, 0
  s_nop 0
  buffer_load_dwordx4 v18, s[12:15], s37 offen lds
  buffer_load_dwordx4 v19, s[12:15], s37 offen offset:1024 lds
  buffer_load_dwordx4 v18, s[12:15], s37 offen offset:2048 lds
  buffer_load_dwordx4 v19, s[12:15], s37 offen offset:3072 lds
  s_add_u32 m0, s34, 0x1000
  s_nop 0
  buffer_load_dwordx4 v20, s[12:15], s37 offen lds
  buffer_load_dwordx4 v21, s[12:15], s37 offen offset:1024 lds
  buffer_load_dwordx4 v20, s[12:15], s37 offen offset:2048 lds
  buffer_load_dwordx4 v21, s[12:15], s37 offen offset:3072 lds
  s_add_u32 s37, s37, 0x2000
  s_and_b32 s37, s37, 0x1ffff
  s_waitcnt vmcnt(16)
  ds_read_b128 a[164:167], v30 offset:8192
  ds_read_b128 a[168:171], v31 offset:8192
  v_cvt_pk_bf16_f32 v76, v224, v225
  v_cvt_pk_bf16_f32 v77, v226, v227
  v_cvt_pk_bf16_f32 v78, v240, v241
  v_cvt_pk_bf16_f32 v79, v242, v243
  v_cvt_pk_bf16_f32 v92, v228, v229
  v_cvt_pk_bf16_f32 v93, v230, v231
  v_cvt_pk_bf16_f32 v94, v244, v245
  v_cvt_pk_bf16_f32 v95, v246, v247
  v_cvt_pk_bf16_f32 v108, v232, v233
  v_cvt_pk_bf16_f32 v109, v234, v235
  v_cvt_pk_bf16_f32 v110, v248, v249
  v_cvt_pk_bf16_f32 v111, v250, v251
  v_cvt_pk_bf16_f32 v124, v236, v237
  v_cvt_pk_bf16_f32 v125, v238, v239
  v_cvt_pk_bf16_f32 v126, v252, v253
  v_cvt_pk_bf16_f32 v127, v254, v255
  v_add_u32 v22, s34, v44
  v_xor_b32 v23, 32, v22
  v_xor_b32 v24, 64, v22
  v_xor_b32 v25, 0x60, v22
  v_xor_b32 v26, 0x80, v22
  v_xor_b32 v27, 0xa0, v22
  v_xor_b32 v28, 0xc0, v22
  v_xor_b32 v29, 0xe0, v22
  s_lshl_b32 s35, s32, 15
  s_lshl_b32 s40, s28, 8
  s_add_u32 s35, s35, s40
  s_waitcnt lgkmcnt(0)
  v_mfma_f32_16x16x32_bf16 v[128:131], a[164:167], v[64:67], 0
  ds_read_b128 a[172:175], v32 offset:8192
  v_mfma_f32_16x16x32_bf16 v[132:135], a[164:167], v[80:83], 0
  ds_read_b128 a[176:179], v33 offset:8192
  v_mfma_f32_16x16x32_bf16 v[136:139], a[164:167], v[96:99], 0
  v_mfma_f32_16x16x32_bf16 v[140:143], a[164:167], v[112:115], 0
  v_mfma_f32_16x16x32_bf16 v[128:131], a[168:171], v[68:71], v[128:131]
  v_mfma_f32_16x16x32_bf16 v[132:135], a[168:171], v[84:87], v[132:135]
  v_mfma_f32_16x16x32_bf16 v[136:139], a[168:171], v[100:103], v[136:139]
  v_mfma_f32_16x16x32_bf16 v[140:143], a[168:171], v[116:119], v[140:143]
  s_waitcnt lgkmcnt(0)
  v_mfma_f32_16x16x32_bf16 v[128:131], a[172:175], v[72:75], v[128:131]
  ds_read_b128 a[164:167], v30 offset:12288
  v_mfma_f32_16x16x32_bf16 v[132:135], a[172:175], v[88:91], v[132:135]
  ds_read_b128 a[168:171], v31 offset:12288
  v_mfma_f32_16x16x32_bf16 v[136:139], a[172:175], v[104:107], v[136:139]
  v_mfma_f32_16x16x32_bf16 v[140:143], a[172:175], v[120:123], v[140:143]
  v_mfma_f32_16x16x32_bf16 v[128:131], a[176:179], v[76:79], v[128:131]
  v_mfma_f32_16x16x32_bf16 v[132:135], a[176:179], v[92:95], v[132:135]
  v_mfma_f32_16x16x32_bf16 v[136:139], a[176:179], v[108:111], v[136:139]
  v_mfma_f32_16x16x32_bf16 v[140:143], a[176:179], v[124:127], v[140:143]
  s_waitcnt lgkmcnt(0)
  v_mfma_f32_16x16x32_bf16 v[144:147], a[164:167], v[64:67], 0
  ds_read_b128 a[172:175], v32 offset:12288
  v_mfma_f32_16x16x32_bf16 v[148:151], a[164:167], v[80:83], 0
  ds_read_b128 a[176:179], v33 offset:12288
  v_mfma_f32_16x16x32_bf16 v[152:155], a[164:167], v[96:99], 0
  v_mfma_f32_16x16x32_bf16 v[156:159], a[164:167], v[112:115], 0
  v_mfma_f32_16x16x32_bf16 v[144:147], a[168:171], v[68:71], v[144:147]
  v_mfma_f32_16x16x32_bf16 v[148:151], a[168:171], v[84:87], v[148:151]
  v_mfma_f32_16x16x32_bf16 v[152:155], a[168:171], v[100:103], v[152:155]
  v_mfma_f32_16x16x32_bf16 v[156:159], a[168:171], v[116:119], v[156:159]
  s_add_u32 m0, s33, 0x2000
  s_waitcnt lgkmcnt(0)
  v_mfma_f32_16x16x32_bf16 v[144:147], a[172:175], v[72:75], v[144:147]
  buffer_load_dwordx4 v10, s[8:11], s36 offen lds
  v_mfma_f32_16x16x32_bf16 v[148:151], a[172:175], v[88:91], v[148:151]
  buffer_load_dwordx4 v11, s[8:11], s36 offen offset:1024 lds
  v_mfma_f32_16x16x32_bf16 v[152:155], a[172:175], v[104:107], v[152:155]
  buffer_load_dwordx4 v12, s[8:11], s36 offen offset:2048 lds
  v_mfma_f32_16x16x32_bf16 v[156:159], a[172:175], v[120:123], v[156:159]
  buffer_load_dwordx4 v13, s[8:11], s36 offen offset:3072 lds
  s_add_u32 m0, s33, 0x3000
  v_mfma_f32_16x16x32_bf16 v[144:147], a[176:179], v[76:79], v[144:147]
  buffer_load_dwordx4 v14, s[8:11], s36 offen lds
  v_mfma_f32_16x16x32_bf16 v[148:151], a[176:179], v[92:95], v[148:151]
  buffer_load_dwordx4 v15, s[8:11], s36 offen offset:1024 lds
  v_mfma_f32_16x16x32_bf16 v[152:155], a[176:179], v[108:111], v[152:155]
  buffer_load_dwordx4 v16, s[8:11], s36 offen offset:2048 lds
  v_mfma_f32_16x16x32_bf16 v[156:159], a[176:179], v[124:127], v[156:159]
  buffer_load_dwordx4 v17, s[8:11], s36 offen offset:3072 lds
  s_add_u32 s36, s36, 0x2000
  s_and_b32 s36, s36, 0x1ffff
  v_max3_f32 v36, v128, v129, v130
  v_max3_f32 v36, v36, v131, v144
  v_max3_f32 v36, v36, v145, v146
  v_max_f32 v36, v36, v147
  v_max3_f32 v37, v132, v133, v134
  v_max3_f32 v37, v37, v135, v148
  v_max3_f32 v37, v37, v149, v150
  v_max_f32 v37, v37, v151
  v_max3_f32 v38, v136, v137, v138
  v_max3_f32 v38, v38, v139, v152
  v_max3_f32 v38, v38, v153, v154
  v_max_f32 v38, v38, v155
  v_max3_f32 v39, v140, v141, v142
  v_max3_f32 v39, v39, v143, v156
  v_max3_f32 v39, v39, v157, v158
  v_max_f32 v39, v39, v159
  v_mov_b32 v40, v36
  v_mov_b32 v41, v37
  v_mov_b32 v42, v38
  v_mov_b32 v43, v39
  v_permlane32_swap_b32 v36, v40
  v_permlane32_swap_b32 v37, v41
  v_permlane32_swap_b32 v38, v42
  v_permlane32_swap_b32 v39, v43
  v_max_f32 v36, v36, v40
  v_max_f32 v37, v37, v41
  v_max_f32 v38, v38, v42
  v_max_f32 v39, v39, v43
  v_mov_b32 v40, v36
  v_mov_b32 v41, v37
  v_mov_b32 v42, v38
  v_mov_b32 v43, v39
  v_permlane16_swap_b32 v36, v40
  v_permlane16_swap_b32 v37, v41
  v_permlane16_swap_b32 v38, v42
  v_permlane16_swap_b32 v39, v43
  v_max_f32 v36, v36, v40
  v_max_f32 v37, v37, v41
  v_max_f32 v38, v38, v42
  v_max_f32 v39, v39, v43
  v_sub_f32 v208, 0, v36
  v_sub_f32 v209, 0, v36
  v_sub_f32 v210, 0, v36
  v_sub_f32 v211, 0, v36
  v_sub_f32 v212, 0, v37
  v_sub_f32 v213, 0, v37
  v_sub_f32 v214, 0, v37
  v_sub_f32 v215, 0, v37
  v_sub_f32 v216, 0, v38
  v_sub_f32 v217, 0, v38
  v_sub_f32 v218, 0, v38
  v_sub_f32 v219, 0, v38
  v_sub_f32 v220, 0, v39
  v_sub_f32 v221, 0, v39
  v_sub_f32 v222, 0, v39
  v_sub_f32 v223, 0, v39
  v_sub_f32 v128, v128, v36
  v_sub_f32 v129, v129, v36
  v_sub_f32 v130, v130, v36
  v_sub_f32 v131, v131, v36
  v_sub_f32 v144, v144, v36
  v_sub_f32 v145, v145, v36
  v_sub_f32 v146, v146, v36
  v_sub_f32 v147, v147, v36
  v_sub_f32 v132, v132, v37
  v_sub_f32 v133, v133, v37
  v_sub_f32 v134, v134, v37
  v_sub_f32 v135, v135, v37
  v_sub_f32 v148, v148, v37
  v_sub_f32 v149, v149, v37
  v_sub_f32 v150, v150, v37
  v_sub_f32 v151, v151, v37
  v_sub_f32 v136, v136, v38
  v_sub_f32 v137, v137, v38
  v_sub_f32 v138, v138, v38
  v_sub_f32 v139, v139, v38
  v_sub_f32 v152, v152, v38
  v_sub_f32 v153, v153, v38
  v_sub_f32 v154, v154, v38
  v_sub_f32 v155, v155, v38
  v_sub_f32 v140, v140, v39
  v_sub_f32 v141, v141, v39
  v_sub_f32 v142, v142, v39
  v_sub_f32 v143, v143, v39
  v_sub_f32 v156, v156, v39
  v_sub_f32 v157, v157, v39
  v_sub_f32 v158, v158, v39
  v_sub_f32 v159, v159, v39
  s_waitcnt vmcnt(16)
  ds_read_b128 a[164:167], v30 offset:16384
  ds_read_b128 a[168:171], v31 offset:16384
  v_exp_f32 v128, v128
  v_exp_f32 v129, v129
  v_exp_f32 v130, v130
  v_exp_f32 v131, v131
  v_exp_f32 v144, v144
  v_exp_f32 v145, v145
  v_exp_f32 v146, v146
  v_exp_f32 v147, v147
  v_exp_f32 v132, v132
  v_exp_f32 v133, v133
  v_exp_f32 v134, v134
  v_exp_f32 v135, v135
  v_exp_f32 v148, v148
  v_exp_f32 v149, v149
  v_exp_f32 v150, v150
  v_exp_f32 v151, v151
  v_exp_f32 v136, v136
  v_exp_f32 v137, v137
  v_exp_f32 v138, v138
  v_exp_f32 v139, v139
  s_mov_b32 s38, 7
L_ga_2:
  s_waitcnt lgkmcnt(0)
  v_mfma_f32_16x16x32_bf16 v[160:163], a[164:167], v[64:67], v[208:211]
  ds_read_b128 a[172:175], v32 offset:16384
  v_cvt_pk_bf16_f32 v192, v128, v129
  v_cvt_pk_bf16_f32 v193, v130, v131
  v_mfma_f32_16x16x32_bf16 v[164:167], a[164:167], v[80:83], v[212:215]
  ds_read_b128 a[176:179], v33 offset:16384
  v_cvt_pk_bf16_f32 v194, v144, v145
  v_cvt_pk_bf16_f32 v195, v146, v147
  v_mfma_f32_16x16x32_bf16 v[168:171], a[164:167], v[96:99], v[216:219]
  s_add_u32 m0, s34, 0x2000
  v_cvt_pk_bf16_f32 v196, v132, v133
  v_cvt_pk_bf16_f32 v197, v134, v135
  v_mfma_f32_16x16x32_bf16 v[172:175], a[164:167], v[112:115], v[220:223]
  buffer_load_dwordx4 v18, s[12:15], s37 offen lds
  v_cvt_pk_bf16_f32 v198, v148, v149
  v_mfma_f32_16x16x32_bf16 v[160:163], a[168:171], v[68:71], v[160:163]
  v_exp_f32 v152, v152
  v_cvt_pk_bf16_f32 v199, v150, v151
  v_mfma_f32_16x16x32_bf16 v[164:167], a[168:171], v[84:87], v[164:167]
  v_exp_f32 v153, v153
  v_cvt_pk_bf16_f32 v200, v136, v137
  v_mfma_f32_16x16x32_bf16 v[168:171], a[168:171], v[100:103], v[168:171]
  buffer_load_dwordx4 v19, s[12:15], s37 offen offset:1024 lds
  v_cvt_pk_bf16_f32 v201, v138, v139
  v_mfma_f32_16x16x32_bf16 v[172:175], a[168:171], v[116:119], v[172:175]
  v_exp_f32 v154, v154
  s_waitcnt lgkmcnt(0)
  v_mfma_f32_16x16x32_bf16 v[160:163], a[172:175], v[72:75], v[160:163]
  ds_read_b128 a[164:167], v30 offset:20480
  v_exp_f32 v155, v155
  v_mfma_f32_16x16x32_bf16 v[164:167], a[172:175], v[88:91], v[164:167]
  ds_read_b128 a[168:171], v31 offset:20480
  v_cvt_pk_bf16_f32 v202, v152, v153
  v_mfma_f32_16x16x32_bf16 v[168:171], a[172:175], v[104:107], v[168:171]
  v_exp_f32 v140, v140
  v_mfma_f32_16x16x32_bf16 v[172:175], a[172:175], v[120:123], v[172:175]
  buffer_load_dwordx4 v18, s[12:15], s37 offen offset:2048 lds
  v_mfma_f32_16x16x32_bf16 v[160:163], a[176:179], v[76:79], v[160:163]
  v_exp_f32 v141, v141
  v_mfma_f32_16x16x32_bf16 v[164:167], a[176:179], v[92:95], v[164:167]
  v_exp_f32 v142, v142
  v_mfma_f32_16x16x32_bf16 v[168:171], a[176:179], v[108:111], v[168:171]
  buffer_load_dwordx4 v19, s[12:15], s37 offen offset:3072 lds
  v_mfma_f32_16x16x32_bf16 v[172:175], a[176:179], v[124:127], v[172:175]
  v_cvt_pk_bf16_f32 v203, v154, v155
  s_waitcnt lgkmcnt(0)
  v_mfma_f32_16x16x32_bf16 v[176:179], a[164:167], v[64:67], v[208:211]
  ds_read_b128 a[172:175], v32 offset:20480
  v_exp_f32 v143, v143
  v_mfma_f32_16x16x32_bf16 v[180:183], a[164:167], v[80:83], v[212:215]
  ds_read_b128 a[176:179], v33 offset:20480
  v_cvt_pk_bf16_f32 v204, v140, v141
  v_mfma_f32_16x16x32_bf16 v[184:187], a[164:167], v[96:99], v[216:219]
  s_add_u32 m0, s34, 0x3000
  v_cvt_pk_bf16_f32 v205, v142, v143
  v_mfma_f32_16x16x32_bf16 v[188:191], a[164:167], v[112:115], v[220:223]
  buffer_load_dwordx4 v20, s[12:15], s37 offen lds
  v_mfma_f32_16x16x32_bf16 v[176:179], a[168:171], v[68:71], v[176:179]
  v_exp_f32 v156, v156
  v_mfma_f32_16x16x32_bf16 v[180:183], a[168:171], v[84:87], v[180:183]
  v_exp_f32 v157, v157
  v_mfma_f32_16x16x32_bf16 v[184:187], a[168:171], v[100:103], v[184:187]
  buffer_load_dwordx4 v21, s[12:15], s37 offen offset:1024 lds
  v_mfma_f32_16x16x32_bf16 v[188:191], a[168:171], v[116:119], v[188:191]
  v_exp_f32 v158, v158
  s_waitcnt lgkmcnt(0)
  v_mfma_f32_16x16x32_bf16 v[176:179], a[172:175], v[72:75], v[176:179]
  s_waitcnt vmcnt(14)
  ds_read_b64_tr_b16 a[148:149], v22
  v_mfma_f32_16x16x32_bf16 v[180:183], a[172:175], v[88:91], v[180:183]
  ds_read_b64_tr_b16 a[150:151], v22 offset:4096
  v_mfma_f32_16x16x32_bf16 v[184:187], a[172:175], v[104:107], v[184:187]
  ds_read_b64_tr_b16 a[152:153], v23
  v_exp_f32 v159, v159
  v_mfma_f32_16x16x32_bf16 v[188:191], a[172:175], v[120:123], v[188:191]
  ds_read_b64_tr_b16 a[154:155], v23 offset:4096
  v_cvt_pk_bf16_f32 v206, v156, v157
  v_mfma_f32_16x16x32_bf16 v[176:179], a[176:179], v[76:79], v[176:179]
  buffer_load_dwordx4 v20, s[12:15], s37 offen offset:2048 lds
  v_mfma_f32_16x16x32_bf16 v[180:183], a[176:179], v[92:95], v[180:183]
  v_cvt_pk_bf16_f32 v207, v158, v159
  v_mfma_f32_16x16x32_bf16 v[184:187], a[176:179], v[108:111], v[184:187]
  buffer_load_dwordx4 v21, s[12:15], s37 offen offset:3072 lds
  v_mfma_f32_16x16x32_bf16 v[188:191], a[176:179], v[124:127], v[188:191]
  s_add_u32 s37, s37, 0x2000
  s_and_b32 s37, s37, 0x1ffff
  v_mfma_f32_16x16x32_bf16 a[128:131], a[144:147], v[192:195], a[128:131]
  v_mfma_f32_16x16x32_bf16 a[132:135], a[144:147], v[196:199], a[132:135]
  s_add_u32 m0, s33, 0x4000
  v_exp_f32 v160, v160
  v_mfma_f32_16x16x32_bf16 a[136:139], a[144:147], v[200:203], a[136:139]
  buffer_load_dwordx4 v10, s[8:11], s36 offen lds
  v_mfma_f32_16x16x32_bf16 a[140:143], a[144:147], v[204:207], a[140:143]
  v_exp_f32 v161, v161
  s_waitcnt lgkmcnt(0)
  v_mfma_f32_16x16x32_bf16 a[0:3], a[148:151], v[192:195], a[0:3]
  ds_read_b64_tr_b16 a[156:157], v24
  ds_read_b64_tr_b16 a[158:159], v24 offset:4096
  v_mfma_f32_16x16x32_bf16 a[4:7], a[148:151], v[196:199], a[4:7]
  ds_read_b64_tr_b16 a[160:161], v25
  ds_read_b64_tr_b16 a[162:163], v25 offset:4096
  v_mfma_f32_16x16x32_bf16 a[8:11], a[148:151], v[200:203], a[8:11]
  v_exp_f32 v162, v162
  v_mfma_f32_16x16x32_bf16 a[12:15], a[148:151], v[204:207], a[12:15]
  v_exp_f32 v163, v163
  v_mfma_f32_16x16x32_bf16 a[16:19], a[152:155], v[192:195], a[16:19]
  buffer_load_dwordx4 v11, s[8:11], s36 offen offset:1024 lds
  v_mfma_f32_16x16x32_bf16 a[20:23], a[152:155], v[196:199], a[20:23]
  v_exp_f32 v176, v176
  v_mfma_f32_16x16x32_bf16 a[24:27], a[152:155], v[200:203], a[24:27]
  v_exp_f32 v177, v177
  v_mfma_f32_16x16x32_bf16 a[28:31], a[152:155], v[204:207], a[28:31]
  v_exp_f32 v178, v178
  s_waitcnt lgkmcnt(0)
  v_mfma_f32_16x16x32_bf16 a[32:35], a[156:159], v[192:195], a[32:35]
  ds_read_b64_tr_b16 a[148:149], v26
  ds_read_b64_tr_b16 a[150:151], v26 offset:4096
  v_mfma_f32_16x16x32_bf16 a[36:39], a[156:159], v[196:199], a[36:39]
  ds_read_b64_tr_b16 a[152:153], v27
  ds_read_b64_tr_b16 a[154:155], v27 offset:4096
  v_mfma_f32_16x16x32_bf16 a[40:43], a[156:159], v[200:203], a[40:43]
  buffer_load_dwordx4 v12, s[8:11], s36 offen offset:2048 lds
  v_mfma_f32_16x16x32_bf16 a[44:47], a[156:159], v[204:207], a[44:47]
  v_exp_f32 v179, v179
  v_mfma_f32_16x16x32_bf16 a[48:51], a[160:163], v[192:195], a[48:51]
  buffer_load_dwordx4 v13, s[8:11], s36 offen offset:3072 lds
  v_mfma_f32_16x16x32_bf16 a[52:55], a[160:163], v[196:199], a[52:55]
  v_exp_f32 v164, v164
  v_mfma_f32_16x16x32_bf16 a[56:59], a[160:163], v[200:203], a[56:59]
  v_exp_f32 v165, v165
  v_mfma_f32_16x16x32_bf16 a[60:63], a[160:163], v[204:207], a[60:63]
  v_exp_f32 v166, v166
  s_waitcnt lgkmcnt(0)
  v_mfma_f32_16x16x32_bf16 a[64:67], a[148:151], v[192:195], a[64:67]
  ds_read_b64_tr_b16 a[156:157], v28
  ds_read_b64_tr_b16 a[158:159], v28 offset:4096
  v_mfma_f32_16x16x32_bf16 a[68:71], a[148:151], v[196:199], a[68:71]
  ds_read_b64_tr_b16 a[160:161], v29
  ds_read_b64_tr_b16 a[162:163], v29 offset:4096
  s_add_u32 m0, s33, 0x5000
  v_mfma_f32_16x16x32_bf16 a[72:75], a[148:151], v[200:203], a[72:75]
  buffer_load_dwordx4 v14, s[8:11], s36 offen lds
  v_mfma_f32_16x16x32_bf16 a[76:79], a[148:151], v[204:207], a[76:79]
  v_exp_f32 v167, v167
  v_mfma_f32_16x16x32_bf16 a[80:83], a[152:155], v[192:195], a[80:83]
  buffer_load_dwordx4 v15, s[8:11], s36 offen offset:1024 lds
  v_mfma_f32_16x16x32_bf16 a[84:87], a[152:155], v[196:199], a[84:87]
  v_exp_f32 v180, v180
  v_mfma_f32_16x16x32_bf16 a[88:91], a[152:155], v[200:203], a[88:91]
  v_exp_f32 v181, v181
  v_mfma_f32_16x16x32_bf16 a[92:95], a[152:155], v[204:207], a[92:95]
  v_exp_f32 v182, v182
  s_waitcnt lgkmcnt(0)
  v_mfma_f32_16x16x32_bf16 a[96:99], a[156:159], v[192:195], a[96:99]
  s_waitcnt vmcnt(14)
  ds_read_b128 a[164:167], v30 offset:8192
  ds_read_b128 a[168:171], v31 offset:8192
  v_mfma_f32_16x16x32_bf16 a[100:103], a[156:159], v[196:199], a[100:103]
  v_exp_f32 v183, v183
  v_mfma_f32_16x16x32_bf16 a[104:107], a[156:159], v[200:203], a[104:107]
  buffer_load_dwordx4 v16, s[8:11], s36 offen offset:2048 lds
  v_mfma_f32_16x16x32_bf16 a[108:111], a[156:159], v[204:207], a[108:111]
  v_exp_f32 v168, v168
  v_mfma_f32_16x16x32_bf16 a[112:115], a[160:163], v[192:195], a[112:115]
  buffer_load_dwordx4 v17, s[8:11], s36 offen offset:3072 lds
  v_mfma_f32_16x16x32_bf16 a[116:119], a[160:163], v[196:199], a[116:119]
  s_add_u32 s36, s36, 0x2000
  v_exp_f32 v169, v169
  v_mfma_f32_16x16x32_bf16 a[120:123], a[160:163], v[200:203], a[120:123]
  s_and_b32 s36, s36, 0x1ffff
  v_exp_f32 v170, v170
  v_mfma_f32_16x16x32_bf16 a[124:127], a[160:163], v[204:207], a[124:127]
  v_exp_f32 v171, v171
  s_waitcnt lgkmcnt(0)
  v_mfma_f32_16x16x32_bf16 v[128:131], a[164:167], v[64:67], v[208:211]
  ds_read_b128 a[172:175], v32 offset:8192
  v_cvt_pk_bf16_f32 v192, v160, v161
  v_cvt_pk_bf16_f32 v193, v162, v163
  v_mfma_f32_16x16x32_bf16 v[132:135], a[164:167], v[80:83], v[212:215]
  ds_read_b128 a[176:179], v33 offset:8192
  v_cvt_pk_bf16_f32 v194, v176, v177
  v_cvt_pk_bf16_f32 v195, v178, v179
  v_mfma_f32_16x16x32_bf16 v[136:139], a[164:167], v[96:99], v[216:219]
  s_add_u32 m0, s34, 0
  v_cvt_pk_bf16_f32 v196, v164, v165
  v_cvt_pk_bf16_f32 v197, v166, v167
  v_mfma_f32_16x16x32_bf16 v[140:143], a[164:167], v[112:115], v[220:223]
  buffer_load_dwordx4 v18, s[12:15], s37 offen lds
  v_cvt_pk_bf16_f32 v198, v180, v181
  v_mfma_f32_16x16x32_bf16 v[128:131], a[168:171], v[68:71], v[128:131]
  v_exp_f32 v184, v184
  v_cvt_pk_bf16_f32 v199, v182, v183
  v_mfma_f32_16x16x32_bf16 v[132:135], a[168:171], v[84:87], v[132:135]
  v_exp_f32 v185, v185
  v_cvt_pk_bf16_f32 v200, v168, v169
  v_mfma_f32_16x16x32_bf16 v[136:139], a[168:171], v[100:103], v[136:139]
  buffer_load_dwordx4 v19, s[12:15], s37 offen offset:1024 lds
  v_cvt_pk_bf16_f32 v201, v170, v171
  v_mfma_f32_16x16x32_bf16 v[140:143], a[168:171], v[116:119], v[140:143]
  v_exp_f32 v186, v186
  s_waitcnt lgkmcnt(0)
  v_mfma_f32_16x16x32_bf16 v[128:131], a[172:175], v[72:75], v[128:131]
  ds_read_b128 a[164:167], v30 offset:12288
  v_exp_f32 v187, v187
  v_mfma_f32_16x16x32_bf16 v[132:135], a[172:175], v[88:91], v[132:135]
  ds_read_b128 a[168:171], v31 offset:12288
  v_cvt_pk_bf16_f32 v202, v184, v185
  v_mfma_f32_16x16x32_bf16 v[136:139], a[172:175], v[104:107], v[136:139]
  v_exp_f32 v172, v172
  v_mfma_f32_16x16x32_bf16 v[140:143], a[172:175], v[120:123], v[140:143]
  buffer_load_dwordx4 v18, s[12:15], s37 offen offset:2048 lds
  v_mfma_f32_16x16x32_bf16 v[128:131], a[176:179], v[76:79], v[128:131]
  v_exp_f32 v173, v173
  v_mfma_f32_16x16x32_bf16 v[132:135], a[176:179], v[92:95], v[132:135]
  v_exp_f32 v174, v174
  v_mfma_f32_16x16x32_bf16 v[136:139], a[176:179], v[108:111], v[136:139]
  buffer_load_dwordx4 v19, s[12:15], s37 offen offset:3072 lds
  v_mfma_f32_16x16x32_bf16 v[140:143], a[176:179], v[124:127], v[140:143]
  v_cvt_pk_bf16_f32 v203, v186, v187
  s_waitcnt lgkmcnt(0)
  v_mfma_f32_16x16x32_bf16 v[144:147], a[164:167], v[64:67], v[208:211]
  ds_read_b128 a[172:175], v32 offset:12288
  v_exp_f32 v175, v175
  v_mfma_f32_16x16x32_bf16 v[148:151], a[164:167], v[80:83], v[212:215]
  ds_read_b128 a[176:179], v33 offset:12288
  v_cvt_pk_bf16_f32 v204, v172, v173
  v_mfma_f32_16x16x32_bf16 v[152:155], a[164:167], v[96:99], v[216:219]
  s_add_u32 m0, s34, 0x1000
  v_cvt_pk_bf16_f32 v205, v174, v175
  v_mfma_f32_16x16x32_bf16 v[156:159], a[164:167], v[112:115], v[220:223]
  buffer_load_dwordx4 v20, s[12:15], s37 offen lds
  v_mfma_f32_16x16x32_bf16 v[144:147], a[168:171], v[68:71], v[144:147]
  v_exp_f32 v188, v188
  v_mfma_f32_16x16x32_bf16 v[148:151], a[168:171], v[84:87], v[148:151]
  v_exp_f32 v189, v189
  v_mfma_f32_16x16x32_bf16 v[152:155], a[168:171], v[100:103], v[152:155]
  buffer_load_dwordx4 v21, s[12:15], s37 offen offset:1024 lds
  v_mfma_f32_16x16x32_bf16 v[156:159], a[168:171], v[116:119], v[156:159]
  v_exp_f32 v190, v190
  s_waitcnt lgkmcnt(0)
  v_mfma_f32_16x16x32_bf16 v[144:147], a[172:175], v[72:75], v[144:147]
  s_waitcnt vmcnt(14)
  ds_read_b64_tr_b16 a[148:149], v22 offset:8192
  v_mfma_f32_16x16x32_bf16 v[148:151], a[172:175], v[88:91], v[148:151]
  ds_read_b64_tr_b16 a[150:151], v22 offset:12288
  v_mfma_f32_16x16x32_bf16 v[152:155], a[172:175], v[104:107], v[152:155]
  ds_read_b64_tr_b16 a[152:153], v23 offset:8192
  v_exp_f32 v191, v191
  v_mfma_f32_16x16x32_bf16 v[156:159], a[172:175], v[120:123], v[156:159]
  ds_read_b64_tr_b16 a[154:155], v23 offset:12288
  v_cvt_pk_bf16_f32 v206, v188, v189
  v_mfma_f32_16x16x32_bf16 v[144:147], a[176:179], v[76:79], v[144:147]
  buffer_load_dwordx4 v20, s[12:15], s37 offen offset:2048 lds
  v_mfma_f32_16x16x32_bf16 v[148:151], a[176:179], v[92:95], v[148:151]
  v_cvt_pk_bf16_f32 v207, v190, v191
  v_mfma_f32_16x16x32_bf16 v[152:155], a[176:179], v[108:111], v[152:155]
  buffer_load_dwordx4 v21, s[12:15], s37 offen offset:3072 lds
  v_mfma_f32_16x16x32_bf16 v[156:159], a[176:179], v[124:127], v[156:159]
  s_add_u32 s37, s37, 0x2000
  s_and_b32 s37, s37, 0x1ffff
  v_mfma_f32_16x16x32_bf16 a[128:131], a[144:147], v[192:195], a[128:131]
  v_mfma_f32_16x16x32_bf16 a[132:135], a[144:147], v[196:199], a[132:135]
  s_add_u32 m0, s33, 0x2000
  v_exp_f32 v128, v128
  v_mfma_f32_16x16x32_bf16 a[136:139], a[144:147], v[200:203], a[136:139]
  buffer_load_dwordx4 v10, s[8:11], s36 offen lds
  v_mfma_f32_16x16x32_bf16 a[140:143], a[144:147], v[204:207], a[140:143]
  v_exp_f32 v129, v129
  s_waitcnt lgkmcnt(0)
  v_mfma_f32_16x16x32_bf16 a[0:3], a[148:151], v[192:195], a[0:3]
  ds_read_b64_tr_b16 a[156:157], v24 offset:8192
  ds_read_b64_tr_b16 a[158:159], v24 offset:12288
  v_mfma_f32_16x16x32_bf16 a[4:7], a[148:151], v[196:199], a[4:7]
  ds_read_b64_tr_b16 a[160:161], v25 offset:8192
  ds_read_b64_tr_b16 a[162:163], v25 offset:12288
  v_mfma_f32_16x16x32_bf16 a[8:11], a[148:151], v[200:203], a[8:11]
  v_exp_f32 v130, v130
  v_mfma_f32_16x16x32_bf16 a[12:15], a[148:151], v[204:207], a[12:15]
  v_exp_f32 v131, v131
  v_mfma_f32_16x16x32_bf16 a[16:19], a[152:155], v[192:195], a[16:19]
  buffer_load_dwordx4 v11, s[8:11], s36 offen offset:1024 lds
  v_mfma_f32_16x16x32_bf16 a[20:23], a[152:155], v[196:199], a[20:23]
  v_exp_f32 v144, v144
  v_mfma_f32_16x16x32_bf16 a[24:27], a[152:155], v[200:203], a[24:27]
  v_exp_f32 v145, v145
  v_mfma_f32_16x16x32_bf16 a[28:31], a[152:155], v[204:207], a[28:31]
  v_exp_f32 v146, v146
  s_waitcnt lgkmcnt(0)
  v_mfma_f32_16x16x32_bf16 a[32:35], a[156:159], v[192:195], a[32:35]
  ds_read_b64_tr_b16 a[148:149], v26 offset:8192
  ds_read_b64_tr_b16 a[150:151], v26 offset:12288
  v_mfma_f32_16x16x32_bf16 a[36:39], a[156:159], v[196:199], a[36:39]
  ds_read_b64_tr_b16 a[152:153], v27 offset:8192
  ds_read_b64_tr_b16 a[154:155], v27 offset:12288
  v_mfma_f32_16x16x32_bf16 a[40:43], a[156:159], v[200:203], a[40:43]
  buffer_load_dwordx4 v12, s[8:11], s36 offen offset:2048 lds
  v_mfma_f32_16x16x32_bf16 a[44:47], a[156:159], v[204:207], a[44:47]
  v_exp_f32 v147, v147
  v_mfma_f32_16x16x32_bf16 a[48:51], a[160:163], v[192:195], a[48:51]
  buffer_load_dwordx4 v13, s[8:11], s36 offen offset:3072 lds
  v_mfma_f32_16x16x32_bf16 a[52:55], a[160:163], v[196:199], a[52:55]
  v_exp_f32 v132, v132
  v_mfma_f32_16x16x32_bf16 a[56:59], a[160:163], v[200:203], a[56:59]
  v_exp_f32 v133, v133
  v_mfma_f32_16x16x32_bf16 a[60:63], a[160:163], v[204:207], a[60:63]
  v_exp_f32 v134, v134
  s_waitcnt lgkmcnt(0)
  v_mfma_f32_16x16x32_bf16 a[64:67], a[148:151], v[192:195], a[64:67]
  ds_read_b64_tr_b16 a[156:157], v28 offset:8192
  ds_read_b64_tr_b16 a[158:159], v28 offset:12288
  v_mfma_f32_16x16x32_bf16 a[68:71], a[148:151], v[196:199], a[68:71]
  ds_read_b64_tr_b16 a[160:161], v29 offset:8192
  ds_read_b64_tr_b16 a[162:163], v29 offset:12288
  s_add_u32 m0, s33, 0x3000
  v_mfma_f32_16x16x32_bf16 a[72:75], a[148:151], v[200:203], a[72:75]
  buffer_load_dwordx4 v14, s[8:11], s36 offen lds
  v_mfma_f32_16x16x32_bf16 a[76:79], a[148:151], v[204:207], a[76:79]
  v_exp_f32 v135, v135
  v_mfma_f32_16x16x32_bf16 a[80:83], a[152:155], v[192:195], a[80:83]
  buffer_load_dwordx4 v15, s[8:11], s36 offen offset:1024 lds
  v_mfma_f32_16x16x32_bf16 a[84:87], a[152:155], v[196:199], a[84:87]
  v_exp_f32 v148, v148
  v_mfma_f32_16x16x32_bf16 a[88:91], a[152:155], v[200:203], a[88:91]
  v_exp_f32 v149, v149
  v_mfma_f32_16x16x32_bf16 a[92:95], a[152:155], v[204:207], a[92:95]
  v_exp_f32 v150, v150
  s_waitcnt lgkmcnt(0)
  v_mfma_f32_16x16x32_bf16 a[96:99], a[156:159], v[192:195], a[96:99]
  s_waitcnt vmcnt(14)
  ds_read_b128 a[164:167], v30 offset:16384
  ds_read_b128 a[168:171], v31 offset:16384
  v_mfma_f32_16x16x32_bf16 a[100:103], a[156:159], v[196:199], a[100:103]
  v_exp_f32 v151, v151
  v_mfma_f32_16x16x32_bf16 a[104:107], a[156:159], v[200:203], a[104:107]
  buffer_load_dwordx4 v16, s[8:11], s36 offen offset:2048 lds
  v_mfma_f32_16x16x32_bf16 a[108:111], a[156:159], v[204:207], a[108:111]
  v_exp_f32 v136, v136
  v_mfma_f32_16x16x32_bf16 a[112:115], a[160:163], v[192:195], a[112:115]
  buffer_load_dwordx4 v17, s[8:11], s36 offen offset:3072 lds
  v_mfma_f32_16x16x32_bf16 a[116:119], a[160:163], v[196:199], a[116:119]
  s_add_u32 s36, s36, 0x2000
  v_exp_f32 v137, v137
  v_mfma_f32_16x16x32_bf16 a[120:123], a[160:163], v[200:203], a[120:123]
  s_and_b32 s36, s36, 0x1ffff
  v_exp_f32 v138, v138
  v_mfma_f32_16x16x32_bf16 a[124:127], a[160:163], v[204:207], a[124:127]
  v_exp_f32 v139, v139
  s_sub_u32 s38, s38, 1
  s_cmp_lg_u32 s38, 0
  s_cbranch_scc1 L_ga_2
  s_waitcnt lgkmcnt(0)
  v_mfma_f32_16x16x32_bf16 v[160:163], a[164:167], v[64:67], v[208:211]
  ds_read_b128 a[172:175], v32 offset:16384
  v_cvt_pk_bf16_f32 v192, v128, v129
  v_cvt_pk_bf16_f32 v193, v130, v131
  v_mfma_f32_16x16x32_bf16 v[164:167], a[164:167], v[80:83], v[212:215]
  ds_read_b128 a[176:179], v33 offset:16384
  v_cvt_pk_bf16_f32 v194, v144, v145
  v_cvt_pk_bf16_f32 v195, v146, v147
  v_mfma_f32_16x16x32_bf16 v[168:171], a[164:167], v[96:99], v[216:219]
  s_add_u32 m0, s34, 0x2000
  v_cvt_pk_bf16_f32 v196, v132, v133
  v_cvt_pk_bf16_f32 v197, v134, v135
  v_mfma_f32_16x16x32_bf16 v[172:175], a[164:167], v[112:115], v[220:223]
  buffer_load_dwordx4 v18, s[12:15], s37 offen lds
  v_cvt_pk_bf16_f32 v198, v148, v149
  v_mfma_f32_16x16x32_bf16 v[160:163], a[168:171], v[68:71], v[160:163]
  v_exp_f32 v152, v152
  v_cvt_pk_bf16_f32 v199, v150, v151
  v_mfma_f32_16x16x32_bf16 v[164:167], a[168:171], v[84:87], v[164:167]
  v_exp_f32 v153, v153
  v_cvt_pk_bf16_f32 v200, v136, v137
  v_mfma_f32_16x16x32_bf16 v[168:171], a[168:171], v[100:103], v[168:171]
  buffer_load_dwordx4 v19, s[12:15], s37 offen offset:1024 lds
  v_cvt_pk_bf16_f32 v201, v138, v139
  v_mfma_f32_16x16x32_bf16 v[172:175], a[168:171], v[116:119], v[172:175]
  v_exp_f32 v154, v154
  s_waitcnt lgkmcnt(0)
  v_mfma_f32_16x16x32_bf16 v[160:163], a[172:175], v[72:75], v[160:163]
  ds_read_b128 a[164:167], v30 offset:20480
  v_exp_f32 v155, v155
  v_mfma_f32_16x16x32_bf16 v[164:167], a[172:175], v[88:91], v[164:167]
  ds_read_b128 a[168:171], v31 offset:20480
  v_cvt_pk_bf16_f32 v202, v152, v153
  v_mfma_f32_16x16x32_bf16 v[168:171], a[172:175], v[104:107], v[168:171]
  v_exp_f32 v140, v140
  v_mfma_f32_16x16x32_bf16 v[172:175], a[172:175], v[120:123], v[172:175]
  buffer_load_dwordx4 v18, s[12:15], s37 offen offset:2048 lds
  v_mfma_f32_16x16x32_bf16 v[160:163], a[176:179], v[76:79], v[160:163]
  v_exp_f32 v141, v141
  v_mfma_f32_16x16x32_bf16 v[164:167], a[176:179], v[92:95], v[164:167]
  v_exp_f32 v142, v142
  v_mfma_f32_16x16x32_bf16 v[168:171], a[176:179], v[108:111], v[168:171]
  buffer_load_dwordx4 v19, s[12:15], s37 offen offset:3072 lds
  v_mfma_f32_16x16x32_bf16 v[172:175], a[176:179], v[124:127], v[172:175]
  v_cvt_pk_bf16_f32 v203, v154, v155
  s_waitcnt lgkmcnt(0)
  v_mfma_f32_16x16x32_bf16 v[176:179], a[164:167], v[64:67], v[208:211]
  ds_read_b128 a[172:175], v32 offset:20480
  v_exp_f32 v143, v143
  v_mfma_f32_16x16x32_bf16 v[180:183], a[164:167], v[80:83], v[212:215]
  ds_read_b128 a[176:179], v33 offset:20480
  v_cvt_pk_bf16_f32 v204, v140, v141
  v_mfma_f32_16x16x32_bf16 v[184:187], a[164:167], v[96:99], v[216:219]
  s_add_u32 m0, s34, 0x3000
  v_cvt_pk_bf16_f32 v205, v142, v143
  v_mfma_f32_16x16x32_bf16 v[188:191], a[164:167], v[112:115], v[220:223]
  buffer_load_dwordx4 v20, s[12:15], s37 offen lds
  v_mfma_f32_16x16x32_bf16 v[176:179], a[168:171], v[68:71], v[176:179]
  v_exp_f32 v156, v156
  v_mfma_f32_16x16x32_bf16 v[180:183], a[168:171], v[84:87], v[180:183]
  v_exp_f32 v157, v157
  v_mfma_f32_16x16x32_bf16 v[184:187], a[168:171], v[100:103], v[184:187]
  buffer_load_dwordx4 v21, s[12:15], s37 offen offset:1024 lds
  v_mfma_f32_16x16x32_bf16 v[188:191], a[168:171], v[116:119], v[188:191]
  v_exp_f32 v158, v158
  s_waitcnt lgkmcnt(0)
  v_mfma_f32_16x16x32_bf16 v[176:179], a[172:175], v[72:75], v[176:179]
  s_waitcnt vmcnt(14)
  ds_read_b64_tr_b16 a[148:149], v22
  v_mfma_f32_16x16x32_bf16 v[180:183], a[172:175], v[88:91], v[180:183]
  ds_read_b64_tr_b16 a[150:151], v22 offset:4096
  v_mfma_f32_16x16x32_bf16 v[184:187], a[172:175], v[104:107], v[184:187]
  ds_read_b64_tr_b16 a[152:153], v23
  v_exp_f32 v159, v159
  v_mfma_f32_16x16x32_bf16 v[188:191], a[172:175], v[120:123], v[188:191]
  ds_read_b64_tr_b16 a[154:155], v23 offset:4096
  v_cvt_pk_bf16_f32 v206, v156, v157
  v_mfma_f32_16x16x32_bf16 v[176:179], a[176:179], v[76:79], v[176:179]
  buffer_load_dwordx4 v20, s[12:15], s37 offen offset:2048 lds
  v_mfma_f32_16x16x32_bf16 v[180:183], a[176:179], v[92:95], v[180:183]
  v_cvt_pk_bf16_f32 v207, v158, v159
  v_mfma_f32_16x16x32_bf16 v[184:187], a[176:179], v[108:111], v[184:187]
  buffer_load_dwordx4 v21, s[12:15], s37 offen offset:3072 lds
  v_mfma_f32_16x16x32_bf16 v[188:191], a[176:179], v[124:127], v[188:191]
  s_add_u32 s37, s37, 0x2000
  s_and_b32 s37, s37, 0x1ffff
  v_mfma_f32_16x16x32_bf16 a[128:131], a[144:147], v[192:195], a[128:131]
  v_mfma_f32_16x16x32_bf16 a[132:135], a[144:147], v[196:199], a[132:135]
  s_add_u32 m0, s33, 0
  v_exp_f32 v160, v160
  v_mfma_f32_16x16x32_bf16 a[136:139], a[144:147], v[200:203], a[136:139]
  buffer_load_dwordx4 v2, s[16:19], s35 offen lds
  v_mfma_f32_16x16x32_bf16 a[140:143], a[144:147], v[204:207], a[140:143]
  v_exp_f32 v161, v161
  s_waitcnt lgkmcnt(0)
  v_mfma_f32_16x16x32_bf16 a[0:3], a[148:151], v[192:195], a[0:3]
  ds_read_b64_tr_b16 a[156:157], v24
  ds_read_b64_tr_b16 a[158:159], v24 offset:4096
  v_mfma_f32_16x16x32_bf16 a[4:7], a[148:151], v[196:199], a[4:7]
  ds_read_b64_tr_b16 a[160:161], v25
  ds_read_b64_tr_b16 a[162:163], v25 offset:4096
  v_mfma_f32_16x16x32_bf16 a[8:11], a[148:151], v[200:203], a[8:11]
  v_exp_f32 v162, v162
  v_mfma_f32_16x16x32_bf16 a[12:15], a[148:151], v[204:207], a[12:15]
  v_exp_f32 v163, v163
  v_mfma_f32_16x16x32_bf16 a[16:19], a[152:155], v[192:195], a[16:19]
  buffer_load_dwordx4 v3, s[16:19], s35 offen offset:1024 lds
  v_mfma_f32_16x16x32_bf16 a[20:23], a[152:155], v[196:199], a[20:23]
  v_exp_f32 v176, v176
  v_mfma_f32_16x16x32_bf16 a[24:27], a[152:155], v[200:203], a[24:27]
  v_exp_f32 v177, v177
  v_mfma_f32_16x16x32_bf16 a[28:31], a[152:155], v[204:207], a[28:31]
  v_exp_f32 v178, v178
  s_waitcnt lgkmcnt(0)
  v_mfma_f32_16x16x32_bf16 a[32:35], a[156:159], v[192:195], a[32:35]
  ds_read_b64_tr_b16 a[148:149], v26
  ds_read_b64_tr_b16 a[150:151], v26 offset:4096
  v_mfma_f32_16x16x32_bf16 a[36:39], a[156:159], v[196:199], a[36:39]
  ds_read_b64_tr_b16 a[152:153], v27
  ds_read_b64_tr_b16 a[154:155], v27 offset:4096
  v_mfma_f32_16x16x32_bf16 a[40:43], a[156:159], v[200:203], a[40:43]
  buffer_load_dwordx4 v4, s[16:19], s35 offen offset:2048 lds
  v_mfma_f32_16x16x32_bf16 a[44:47], a[156:159], v[204:207], a[44:47]
  v_exp_f32 v179, v179
  v_mfma_f32_16x16x32_bf16 a[48:51], a[160:163], v[192:195], a[48:51]
  buffer_load_dwordx4 v5, s[16:19], s35 offen offset:3072 lds
  v_mfma_f32_16x16x32_bf16 a[52:55], a[160:163], v[196:199], a[52:55]
  v_exp_f32 v164, v164
  v_mfma_f32_16x16x32_bf16 a[56:59], a[160:163], v[200:203], a[56:59]
  v_exp_f32 v165, v165
  v_mfma_f32_16x16x32_bf16 a[60:63], a[160:163], v[204:207], a[60:63]
  v_exp_f32 v166, v166
  s_waitcnt lgkmcnt(0)
  v_mfma_f32_16x16x32_bf16 a[64:67], a[148:151], v[192:195], a[64:67]
  ds_read_b64_tr_b16 a[156:157], v28
  ds_read_b64_tr_b16 a[158:159], v28 offset:4096
  v_mfma_f32_16x16x32_bf16 a[68:71], a[148:151], v[196:199], a[68:71]
  ds_read_b64_tr_b16 a[160:161], v29
  ds_read_b64_tr_b16 a[162:163], v29 offset:4096
  s_add_u32 m0, s33, 0x1000
  v_mfma_f32_16x16x32_bf16 a[72:75], a[148:151], v[200:203], a[72:75]
  buffer_load_dwordx4 v6, s[16:19], s35 offen lds
  v_mfma_f32_16x16x32_bf16 a[76:79], a[148:151], v[204:207], a[76:79]
  v_exp_f32 v167, v167
  v_mfma_f32_16x16x32_bf16 a[80:83], a[152:155], v[192:195], a[80:83]
  buffer_load_dwordx4 v7, s[16:19], s35 offen offset:1024 lds
  v_mfma_f32_16x16x32_bf16 a[84:87], a[152:155], v[196:199], a[84:87]
  v_exp_f32 v180, v180
  v_mfma_f32_16x16x32_bf16 a[88:91], a[152:155], v[200:203], a[88:91]
  v_exp_f32 v181, v181
  v_mfma_f32_16x16x32_bf16 a[92:95], a[152:155], v[204:207], a[92:95]
  v_exp_f32 v182, v182
  s_waitcnt lgkmcnt(0)
  v_mfma_f32_16x16x32_bf16 a[96:99], a[156:159], v[192:195], a[96:99]
  v_exp_f32 v183, v183
  v_mfma_f32_16x16x32_bf16 a[100:103], a[156:159], v[196:199], a[100:103]
  v_exp_f32 v168, v168
  v_mfma_f32_16x16x32_bf16 a[104:107], a[156:159], v[200:203], a[104:107]
  buffer_load_dwordx4 v8, s[16:19], s35 offen offset:2048 lds
  v_mfma_f32_16x16x32_bf16 a[108:111], a[156:159], v[204:207], a[108:111]
  v_exp_f32 v169, v169
  v_mfma_f32_16x16x32_bf16 a[112:115], a[160:163], v[192:195], a[112:115]
  buffer_load_dwordx4 v9, s[16:19], s35 offen offset:3072 lds
  v_mfma_f32_16x16x32_bf16 a[116:119], a[160:163], v[196:199], a[116:119]
  s_add_u32 s35, s35, 0x8000
  v_exp_f32 v170, v170
  v_mfma_f32_16x16x32_bf16 a[120:123], a[160:163], v[200:203], a[120:123]
  s_and_b32 s35, s35, 0x7ffff
  v_exp_f32 v171, v171
  v_mfma_f32_16x16x32_bf16 a[124:127], a[160:163], v[204:207], a[124:127]
  v_cvt_pk_bf16_f32 v192, v160, v161
  v_cvt_pk_bf16_f32 v193, v162, v163
  v_cvt_pk_bf16_f32 v194, v176, v177
  v_cvt_pk_bf16_f32 v195, v178, v179
  v_exp_f32 v184, v184
  s_waitcnt vmcnt(8)
  ds_read_b64_tr_b16 a[148:149], v22 offset:8192
  ds_read_b64_tr_b16 a[150:151], v22 offset:12288
  ds_read_b64_tr_b16 a[152:153], v23 offset:8192
  ds_read_b64_tr_b16 a[154:155], v23 offset:12288
  v_exp_f32 v185, v185
  v_cvt_pk_bf16_f32 v196, v164, v165
  v_cvt_pk_bf16_f32 v197, v166, v167
  v_cvt_pk_bf16_f32 v198, v180, v181
  v_cvt_pk_bf16_f32 v199, v182, v183
  v_exp_f32 v186, v186
  v_exp_f32 v187, v187
  v_cvt_pk_bf16_f32 v200, v168, v169
  v_cvt_pk_bf16_f32 v201, v170, v171
  v_exp_f32 v172, v172
  v_exp_f32 v173, v173
  v_exp_f32 v174, v174
  v_exp_f32 v175, v175
  v_cvt_pk_bf16_f32 v202, v184, v185
  v_cvt_pk_bf16_f32 v203, v186, v187
  v_exp_f32 v188, v188
  v_exp_f32 v189, v189
  v_exp_f32 v190, v190
  v_exp_f32 v191, v191
  v_cvt_pk_bf16_f32 v204, v172, v173
  v_cvt_pk_bf16_f32 v205, v174, v175
  v_cvt_pk_bf16_f32 v206, v188, v189
  v_cvt_pk_bf16_f32 v207, v190, v191
  v_mfma_f32_16x16x32_bf16 a[128:131], a[144:147], v[192:195], a[128:131]
  v_mfma_f32_16x16x32_bf16 a[132:135], a[144:147], v[196:199], a[132:135]
  s_add_u32 m0, s33, 0x2000
  v_mfma_f32_16x16x32_bf16 a[136:139], a[144:147], v[200:203], a[136:139]
  buffer_load_dwordx4 v2, s[16:19], s35 offen lds
  v_mfma_f32_16x16x32_bf16 a[140:143], a[144:147], v[204:207], a[140:143]
  s_waitcnt lgkmcnt(0)
  v_mfma_f32_16x16x32_bf16 a[0:3], a[148:151], v[192:195], a[0:3]
  ds_read_b64_tr_b16 a[156:157], v24 offset:8192
  ds_read_b64_tr_b16 a[158:159], v24 offset:12288
  v_mfma_f32_16x16x32_bf16 a[4:7], a[148:151], v[196:199], a[4:7]
  ds_read_b64_tr_b16 a[160:161], v25 offset:8192
  ds_read_b64_tr_b16 a[162:163], v25 offset:12288
  v_mfma_f32_16x16x32_bf16 a[8:11], a[148:151], v[200:203], a[8:11]
  v_mfma_f32_16x16x32_bf16 a[12:15], a[148:151], v[204:207], a[12:15]
  v_mfma_f32_16x16x32_bf16 a[16:19], a[152:155], v[192:195], a[16:19]
  buffer_load_dwordx4 v3, s[16:19], s35 offen offset:1024 lds
  v_mfma_f32_16x16x32_bf16 a[20:23], a[152:155], v[196:199], a[20:23]
  v_mfma_f32_16x16x32_bf16 a[24:27], a[152:155], v[200:203], a[24:27]
  v_mfma_f32_16x16x32_bf16 a[28:31], a[152:155], v[204:207], a[28:31]
  s_waitcnt lgkmcnt(0)
  v_mfma_f32_16x16x32_bf16 a[32:35], a[156:159], v[192:195], a[32:35]
  ds_read_b64_tr_b16 a[148:149], v26 offset:8192
  ds_read_b64_tr_b16 a[150:151], v26 offset:12288
  v_mfma_f32_16x16x32_bf16 a[36:39], a[156:159], v[196:199], a[36:39]
  ds_read_b64_tr_b16 a[152:153], v27 offset:8192
  ds_read_b64_tr_b16 a[154:155], v27 offset:12288
  v_mfma_f32_16x16x32_bf16 a[40:43], a[156:159], v[200:203], a[40:43]
  buffer_load_dwordx4 v4, s[16:19], s35 offen offset:2048 lds
  v_mfma_f32_16x16x32_bf16 a[44:47], a[156:159], v[204:207], a[44:47]
  v_mfma_f32_16x16x32_bf16 a[48:51], a[160:163], v[192:195], a[48:51]
  buffer_load_dwordx4 v5, s[16:19], s35 offen offset:3072 lds
  v_mfma_f32_16x16x32_bf16 a[52:55], a[160:163], v[196:199], a[52:55]
  v_mfma_f32_16x16x32_bf16 a[56:59], a[160:163], v[200:203], a[56:59]
  v_mfma_f32_16x16x32_bf16 a[60:63], a[160:163], v[204:207], a[60:63]
  s_waitcnt lgkmcnt(0)
  v_mfma_f32_16x16x32_bf16 a[64:67], a[148:151], v[192:195], a[64:67]
  ds_read_b64_tr_b16 a[156:157], v28 offset:8192
  ds_read_b64_tr_b16 a[158:159], v28 offset:12288
  v_mfma_f32_16x16x32_bf16 a[68:71], a[148:151], v[196:199], a[68:71]
  ds_read_b64_tr_b16 a[160:161], v29 offset:8192
  ds_read_b64_tr_b16 a[162:163], v29 offset:12288
  s_add_u32 m0, s33, 0x3000
  v_mfma_f32_16x16x32_bf16 a[72:75], a[148:151], v[200:203], a[72:75]
  buffer_load_dwordx4 v6, s[16:19], s35 offen lds
  v_mfma_f32_16x16x32_bf16 a[76:79], a[148:151], v[204:207], a[76:79]
  v_mfma_f32_16x16x32_bf16 a[80:83], a[152:155], v[192:195], a[80:83]
  buffer_load_dwordx4 v7, s[16:19], s35 offen offset:1024 lds
  v_mfma_f32_16x16x32_bf16 a[84:87], a[152:155], v[196:199], a[84:87]
  v_mfma_f32_16x16x32_bf16 a[88:91], a[152:155], v[200:203], a[88:91]
  v_mfma_f32_16x16x32_bf16 a[92:95], a[152:155], v[204:207], a[92:95]
  s_waitcnt lgkmcnt(0)
  v_mfma_f32_16x16x32_bf16 a[96:99], a[156:159], v[192:195], a[96:99]
  v_mfma_f32_16x16x32_bf16 a[100:103], a[156:159], v[196:199], a[100:103]
  v_mfma_f32_16x16x32_bf16 a[104:107], a[156:159], v[200:203], a[104:107]
  buffer_load_dwordx4 v8, s[16:19], s35 offen offset:2048 lds
  v_mfma_f32_16x16x32_bf16 a[108:111], a[156:159], v[204:207], a[108:111]
  v_mfma_f32_16x16x32_bf16 a[112:115], a[160:163], v[192:195], a[112:115]
  buffer_load_dwordx4 v9, s[16:19], s35 offen offset:3072 lds
  v_mfma_f32_16x16x32_bf16 a[116:119], a[160:163], v[196:199], a[116:119]
  s_add_u32 s35, s35, 0x8000
  v_mfma_f32_16x16x32_bf16 a[120:123], a[160:163], v[200:203], a[120:123]
  s_and_b32 s35, s35, 0x7ffff
  v_mfma_f32_16x16x32_bf16 a[124:127], a[160:163], v[204:207], a[124:127]
  buffer_load_dwordx2 a[248:249], v63, s[96:99], 0 offen offset:8 sc1
  v_accvgpr_read_b32 v224, a128
  v_accvgpr_read_b32 v225, a132
  v_accvgpr_read_b32 v226, a136
  v_accvgpr_read_b32 v227, a140
  v_add_f32 v36, v224, v225
  v_add_f32 v37, v226, v227
  v_add_f32 v36, v36, v37
  v_cmp_gt_f32 vcc, 0x53800000, v36
  s_nop 3
  s_cmp_eq_u64 vcc, exec
  s_cbranch_scc0 B_slow
B_norm:
  s_barrier
  v_accvgpr_read_b32 v224, a128
  v_accvgpr_read_b32 v225, a132
  v_accvgpr_read_b32 v226, a136
  v_accvgpr_read_b32 v227, a140
  v_rcp_f32 v224, v224
  v_rcp_f32 v225, v225
  v_rcp_f32 v226, v226
  v_rcp_f32 v227, v227
  v_mov_b32 v228, v224
  v_mov_b32 v229, v224
  v_mov_b32 v230, v225
  v_mov_b32 v231, v225
  v_mov_b32 v232, v226
  v_mov_b32 v233, v226
  v_mov_b32 v234, v227
  v_mov_b32 v235, v227
  s_lshl_b32 s40, s28, 2
  s_add_u32 s40, s40, 16
  s_sub_u32 s40, s40, s32
  s_and_b32 s40, s40, 15
  s_lshl_b32 s40, s40, 12
  s_add_u32 s40, s40, 0x18000
  v_add_u32 v236, s40, v35
  s_lshl_b32 s40, s28, 2
  s_add_u32 s40, s40, 17
  s_sub_u32 s40, s40, s32
  s_and_b32 s40, s40, 15
  s_lshl_b32 s40, s40, 12
  s_add_u32 s40, s40, 0x18000
  v_add_u32 v237, s40, v35
  s_lshl_b32 s40, s28, 2
  s_add_u32 s40, s40, 18
  s_sub_u32 s40, s40, s32
  s_and_b32 s40, s40, 15
  s_lshl_b32 s40, s40, 12
  s_add_u32 s40, s40, 0x18000
  v_add_u32 v238, s40, v35
  s_lshl_b32 s40, s28, 2
  s_add_u32 s40, s40, 19
  s_sub_u32 s40, s40, s32
  s_and_b32 s40, s40, 15
  s_lshl_b32 s40, s40, 12
  s_add_u32 s40, s40, 0x18000
  v_add_u32 v239, s40, v35
  v_accvgpr_read_b32 v128, a0
  v_accvgpr_read_b32 v129, a1
  v_accvgpr_read_b32 v130, a2
  v_accvgpr_read_b32 v131, a3
  v_accvgpr_read_b32 v132, a16
  v_accvgpr_read_b32 v133, a17
  v_accvgpr_read_b32 v134, a18
  v_accvgpr_read_b32 v135, a19
  v_pk_mul_f32 v[128:129], v[128:129], v[228:229]
  v_pk_mul_f32 v[130:131], v[130:131], v[228:229]
  v_pk_mul_f32 v[132:133], v[132:133], v[228:229]
  v_pk_mul_f32 v[134:135], v[134:135], v[228:229]
  v_cvt_pk_bf16_f32 v160, v128, v129
  v_cvt_pk_bf16_f32 v161, v130, v131
  v_cvt_pk_bf16_f32 v162, v132, v133
  v_cvt_pk_bf16_f32 v163, v134, v135
  ds_write_b128 v236, v[160:163]
  v_accvgpr_read_b32 v136, a4
  v_accvgpr_read_b32 v137, a5
  v_accvgpr_read_b32 v138, a6
  v_accvgpr_read_b32 v139, a7
  v_accvgpr_read_b32 v140, a20
  v_accvgpr_read_b32 v141, a21
  v_accvgpr_read_b32 v142, a22
  v_accvgpr_read_b32 v143, a23
  v_pk_mul_f32 v[136:137], v[136:137], v[230:231]
  v_pk_mul_f32 v[138:139], v[138:139], v[230:231]
  v_pk_mul_f32 v[140:141], v[140:141], v[230:231]
  v_pk_mul_f32 v[142:143], v[142:143], v[230:231]
  v_cvt_pk_bf16_f32 v164, v136, v137
  v_cvt_pk_bf16_f32 v165, v138, v139
  v_cvt_pk_bf16_f32 v166, v140, v141
  v_cvt_pk_bf16_f32 v167, v142, v143
  ds_write_b128 v236, v[164:167] offset:1024
  v_accvgpr_read_b32 v144, a8
  v_accvgpr_read_b32 v145, a9
  v_accvgpr_read_b32 v146, a10
  v_accvgpr_read_b32 v147, a11
  v_accvgpr_read_b32 v148, a24
  v_accvgpr_read_b32 v149, a25
  v_accvgpr_read_b32 v150, a26
  v_accvgpr_read_b32 v151, a27
  v_pk_mul_f32 v[144:145], v[144:145], v[232:233]
  v_pk_mul_f32 v[146:147], v[146:147], v[232:233]
  v_pk_mul_f32 v[148:149], v[148:149], v[232:233]
  v_pk_mul_f32 v[150:151], v[150:151], v[232:233]
  v_cvt_pk_bf16_f32 v168, v144, v145
  v_cvt_pk_bf16_f32 v169, v146, v147
  v_cvt_pk_bf16_f32 v170, v148, v149
  v_cvt_pk_bf16_f32 v171, v150, v151
  ds_write_b128 v236, v[168:171] offset:2048
  v_accvgpr_read_b32 v152, a12
  v_accvgpr_read_b32 v153, a13
  v_accvgpr_read_b32 v154, a14
  v_accvgpr_read_b32 v155, a15
  v_accvgpr_read_b32 v156, a28
  v_accvgpr_read_b32 v157, a29
  v_accvgpr_read_b32 v158, a30
  v_accvgpr_read_b32 v159, a31
  v_pk_mul_f32 v[152:153], v[152:153], v[234:235]
  v_pk_mul_f32 v[154:155], v[154:155], v[234:235]
  v_pk_mul_f32 v[156:157], v[156:157], v[234:235]
  v_pk_mul_f32 v[158:159], v[158:159], v[234:235]
  v_cvt_pk_bf16_f32 v172, v152, v153
  v_cvt_pk_bf16_f32 v173, v154, v155
  v_cvt_pk_bf16_f32 v174, v156, v157
  v_cvt_pk_bf16_f32 v175, v158, v159
  ds_write_b128 v236, v[172:175] offset:3072
  v_accvgpr_read_b32 v128, a32
  v_accvgpr_read_b32 v129, a33
  v_accvgpr_read_b32 v130, a34
  v_accvgpr_read_b32 v131, a35
  v_accvgpr_read_b32 v132, a48
  v_accvgpr_read_b32 v133, a49
  v_accvgpr_read_b32 v134, a50
  v_accvgpr_read_b32 v135, a51
  v_pk_mul_f32 v[128:129], v[128:129], v[228:229]
  v_pk_mul_f32 v[130:131], v[130:131], v[228:229]
  v_pk_mul_f32 v[132:133], v[132:133], v[228:229]
  v_pk_mul_f32 v[134:135], v[134:135], v[228:229]
  v_cvt_pk_bf16_f32 v176, v128, v129
  v_cvt_pk_bf16_f32 v177, v130, v131
  v_cvt_pk_bf16_f32 v178, v132, v133
  v_cvt_pk_bf16_f32 v179, v134, v135
  ds_write_b128 v237, v[176:179]
  v_accvgpr_read_b32 v136, a36
  v_accvgpr_read_b32 v137, a37
  v_accvgpr_read_b32 v138, a38
  v_accvgpr_read_b32 v139, a39
  v_accvgpr_read_b32 v140, a52
  v_accvgpr_read_b32 v141, a53
  v_accvgpr_read_b32 v142, a54
  v_accvgpr_read_b32 v143, a55
  v_pk_mul_f32 v[136:137], v[136:137], v[230:231]
  v_pk_mul_f32 v[138:139], v[138:139], v[230:231]
  v_pk_mul_f32 v[140:141], v[140:141], v[230:231]
  v_pk_mul_f32 v[142:143], v[142:143], v[230:231]
  v_cvt_pk_bf16_f32 v180, v136, v137
  v_cvt_pk_bf16_f32 v181, v138, v139
  v_cvt_pk_bf16_f32 v182, v140, v141
  v_cvt_pk_bf16_f32 v183, v142, v143
  ds_write_b128 v237, v[180:183] offset:1024
  v_accvgpr_read_b32 v144, a40
  v_accvgpr_read_b32 v145, a41
  v_accvgpr_read_b32 v146, a42
  v_accvgpr_read_b32 v147, a43
  v_accvgpr_read_b32 v148, a56
  v_accvgpr_read_b32 v149, a57
  v_accvgpr_read_b32 v150, a58
  v_accvgpr_read_b32 v151, a59
  v_pk_mul_f32 v[144:145], v[144:145], v[232:233]
  v_pk_mul_f32 v[146:147], v[146:147], v[232:233]
  v_pk_mul_f32 v[148:149], v[148:149], v[232:233]
  v_pk_mul_f32 v[150:151], v[150:151], v[232:233]
  v_cvt_pk_bf16_f32 v184, v144, v145
  v_cvt_pk_bf16_f32 v185, v146, v147
  v_cvt_pk_bf16_f32 v186, v148, v149
  v_cvt_pk_bf16_f32 v187, v150, v151
  ds_write_b128 v237, v[184:187] offset:2048
  v_accvgpr_read_b32 v152, a44
  v_accvgpr_read_b32 v153, a45
  v_accvgpr_read_b32 v154, a46
  v_accvgpr_read_b32 v155, a47
  v_accvgpr_read_b32 v156, a60
  v_accvgpr_read_b32 v157, a61
  v_accvgpr_read_b32 v158, a62
  v_accvgpr_read_b32 v159, a63
  v_pk_mul_f32 v[152:153], v[152:153], v[234:235]
  v_pk_mul_f32 v[154:155], v[154:155], v[234:235]
  v_pk_mul_f32 v[156:157], v[156:157], v[234:235]
  v_pk_mul_f32 v[158:159], v[158:159], v[234:235]
  v_cvt_pk_bf16_f32 v188, v152, v153
  v_cvt_pk_bf16_f32 v189, v154, v155
  v_cvt_pk_bf16_f32 v190, v156, v157
  v_cvt_pk_bf16_f32 v191, v158, v159
  ds_write_b128 v237, v[188:191] offset:3072
  v_accvgpr_read_b32 v128, a64
  v_accvgpr_read_b32 v129, a65
  v_accvgpr_read_b32 v130, a66
  v_accvgpr_read_b32 v131, a67
  v_accvgpr_read_b32 v132, a80
  v_accvgpr_read_b32 v133, a81
  v_accvgpr_read_b32 v134, a82
  v_accvgpr_read_b32 v135, a83
  v_pk_mul_f32 v[128:129], v[128:129], v[228:229]
  v_pk_mul_f32 v[130:131], v[130:131], v[228:229]
  v_pk_mul_f32 v[132:133], v[132:133], v[228:229]
  v_pk_mul_f32 v[134:135], v[134:135], v[228:229]
  v_cvt_pk_bf16_f32 v192, v128, v129
  v_cvt_pk_bf16_f32 v193, v130, v131
  v_cvt_pk_bf16_f32 v194, v132, v133
  v_cvt_pk_bf16_f32 v195, v134, v135
  ds_write_b128 v238, v[192:195]
  v_accvgpr_read_b32 v136, a68
  v_accvgpr_read_b32 v137, a69
  v_accvgpr_read_b32 v138, a70
  v_accvgpr_read_b32 v139, a71
  v_accvgpr_read_b32 v140, a84
  v_accvgpr_read_b32 v141, a85
  v_accvgpr_read_b32 v142, a86
  v_accvgpr_read_b32 v143, a87
  v_pk_mul_f32 v[136:137], v[136:137], v[230:231]
  v_pk_mul_f32 v[138:139], v[138:139], v[230:231]
  v_pk_mul_f32 v[140:141], v[140:141], v[230:231]
  v_pk_mul_f32 v[142:143], v[142:143], v[230:231]
  v_cvt_pk_bf16_f32 v196, v136, v137
  v_cvt_pk_bf16_f32 v197, v138, v139
  v_cvt_pk_bf16_f32 v198, v140, v141
  v_cvt_pk_bf16_f32 v199, v142, v143
  ds_write_b128 v238, v[196:199] offset:1024
  v_accvgpr_read_b32 v144, a72
  v_accvgpr_read_b32 v145, a73
  v_accvgpr_read_b32 v146, a74
  v_accvgpr_read_b32 v147, a75
  v_accvgpr_read_b32 v148, a88
  v_accvgpr_read_b32 v149, a89
  v_accvgpr_read_b32 v150, a90
  v_accvgpr_read_b32 v151, a91
  v_pk_mul_f32 v[144:145], v[144:145], v[232:233]
  v_pk_mul_f32 v[146:147], v[146:147], v[232:233]
  v_pk_mul_f32 v[148:149], v[148:149], v[232:233]
  v_pk_mul_f32 v[150:151], v[150:151], v[232:233]
  v_cvt_pk_bf16_f32 v200, v144, v145
  v_cvt_pk_bf16_f32 v201, v146, v147
  v_cvt_pk_bf16_f32 v202, v148, v149
  v_cvt_pk_bf16_f32 v203, v150, v151
  ds_write_b128 v238, v[200:203] offset:2048
  v_accvgpr_read_b32 v152, a76
  v_accvgpr_read_b32 v153, a77
  v_accvgpr_read_b32 v154, a78
  v_accvgpr_read_b32 v155, a79
  v_accvgpr_read_b32 v156, a92
  v_accvgpr_read_b32 v157, a93
  v_accvgpr_read_b32 v158, a94
  v_accvgpr_read_b32 v159, a95
  v_pk_mul_f32 v[152:153], v[152:153], v[234:235]
  v_pk_mul_f32 v[154:155], v[154:155], v[234:235]
  v_pk_mul_f32 v[156:157], v[156:157], v[234:235]
  v_pk_mul_f32 v[158:159], v[158:159], v[234:235]
  v_cvt_pk_bf16_f32 v204, v152, v153
  v_cvt_pk_bf16_f32 v205, v154, v155
  v_cvt_pk_bf16_f32 v206, v156, v157
  v_cvt_pk_bf16_f32 v207, v158, v159
  ds_write_b128 v238, v[204:207] offset:3072
  v_accvgpr_read_b32 v128, a96
  v_accvgpr_read_b32 v129, a97
  v_accvgpr_read_b32 v130, a98
  v_accvgpr_read_b32 v131, a99
  v_accvgpr_read_b32 v132, a112
  v_accvgpr_read_b32 v133, a113
  v_accvgpr_read_b32 v134, a114
  v_accvgpr_read_b32 v135, a115
  v_pk_mul_f32 v[128:129], v[128:129], v[228:229]
  v_pk_mul_f32 v[130:131], v[130:131], v[228:229]
  v_pk_mul_f32 v[132:133], v[132:133], v[228:229]
  v_pk_mul_f32 v[134:135], v[134:135], v[228:229]
  v_cvt_pk_bf16_f32 v208, v128, v129
  v_cvt_pk_bf16_f32 v209, v130, v131
  v_cvt_pk_bf16_f32 v210, v132, v133
  v_cvt_pk_bf16_f32 v211, v134, v135
  ds_write_b128 v239, v[208:211]
  v_accvgpr_read_b32 v136, a100
  v_accvgpr_read_b32 v137, a101
  v_accvgpr_read_b32 v138, a102
  v_accvgpr_read_b32 v139, a103
  v_accvgpr_read_b32 v140, a116
  v_accvgpr_read_b32 v141, a117
  v_accvgpr_read_b32 v142, a118
  v_accvgpr_read_b32 v143, a119
  v_pk_mul_f32 v[136:137], v[136:137], v[230:231]
  v_pk_mul_f32 v[138:139], v[138:139], v[230:231]
  v_pk_mul_f32 v[140:141], v[140:141], v[230:231]
  v_pk_mul_f32 v[142:143], v[142:143], v[230:231]
  v_cvt_pk_bf16_f32 v212, v136, v137
  v_cvt_pk_bf16_f32 v213, v138, v139
  v_cvt_pk_bf16_f32 v214, v140, v141
  v_cvt_pk_bf16_f32 v215, v142, v143
  ds_write_b128 v239, v[212:215] offset:1024
  v_accvgpr_read_b32 v144, a104
  v_accvgpr_read_b32 v145, a105
  v_accvgpr_read_b32 v146, a106
  v_accvgpr_read_b32 v147, a107
  v_accvgpr_read_b32 v148, a120
  v_accvgpr_read_b32 v149, a121
  v_accvgpr_read_b32 v150, a122
  v_accvgpr_read_b32 v151, a123
  v_pk_mul_f32 v[144:145], v[144:145], v[232:233]
  v_pk_mul_f32 v[146:147], v[146:147], v[232:233]
  v_pk_mul_f32 v[148:149], v[148:149], v[232:233]
  v_pk_mul_f32 v[150:151], v[150:151], v[232:233]
  v_cvt_pk_bf16_f32 v216, v144, v145
  v_cvt_pk_bf16_f32 v217, v146, v147
  v_cvt_pk_bf16_f32 v218, v148, v149
  v_cvt_pk_bf16_f32 v219, v150, v151
  ds_write_b128 v239, v[216:219] offset:2048
  v_accvgpr_read_b32 v152, a108
  v_accvgpr_read_b32 v153, a109
  v_accvgpr_read_b32 v154, a110
  v_accvgpr_read_b32 v155, a111
  v_accvgpr_read_b32 v156, a124
  v_accvgpr_read_b32 v157, a125
  v_accvgpr_read_b32 v158, a126
  v_accvgpr_read_b32 v159, a127
  v_pk_mul_f32 v[152:153], v[152:153], v[234:235]
  v_pk_mul_f32 v[154:155], v[154:155], v[234:235]
  v_pk_mul_f32 v[156:157], v[156:157], v[234:235]
  v_pk_mul_f32 v[158:159], v[158:159], v[234:235]
  v_cvt_pk_bf16_f32 v220, v152, v153
  v_cvt_pk_bf16_f32 v221, v154, v155
  v_cvt_pk_bf16_f32 v222, v156, v157
  v_cvt_pk_bf16_f32 v223, v158, v159
  s_waitcnt lgkmcnt(14)
  ds_write_b128 v239, v[220:223] offset:3072
  v_add_u32 v22, s33, v44
  v_xor_b32 v23, 32, v22
  v_xor_b32 v24, 64, v22
  v_xor_b32 v25, 0x60, v22
  v_xor_b32 v26, 0x80, v22
  v_xor_b32 v27, 0xa0, v22
  v_xor_b32 v28, 0xc0, v22
  v_xor_b32 v29, 0xe0, v22
  s_waitcnt lgkmcnt(0)
  s_barrier
  ds_read_b128 a[180:183], v34
  ds_read_b128 a[184:187], v34 offset:1024
  ds_read_b128 a[188:191], v34 offset:2048
  ds_read_b128 a[192:195], v34 offset:3072
  s_waitcnt vmcnt(9)
  ds_read_b64_tr_b16 a[148:149], v22
  ds_read_b64_tr_b16 a[150:151], v22 offset:4096
  ds_read_b64_tr_b16 a[152:153], v23
  ds_read_b64_tr_b16 a[154:155], v23 offset:4096
  s_waitcnt lgkmcnt(0)
  v_mfma_f32_16x16x32_bf16 v[128:131], a[148:151], a[180:183], 0
  ds_read_b64_tr_b16 a[156:157], v24
  v_mfma_f32_16x16x32_bf16 v[132:135], a[148:151], a[184:187], 0
  ds_read_b64_tr_b16 a[158:159], v24 offset:4096
  s_add_u32 m0, s33, 0x4000
  v_mfma_f32_16x16x32_bf16 v[136:139], a[148:151], a[188:191], 0
  buffer_load_dwordx4 v2, s[16:19], s35 offen lds
  v_mfma_f32_16x16x32_bf16 v[140:143], a[148:151], a[192:195], 0
  ds_read_b64_tr_b16 a[160:161], v25
  v_mfma_f32_16x16x32_bf16 v[144:147], a[152:155], a[180:183], 0
  ds_read_b64_tr_b16 a[162:163], v25 offset:4096
  v_mfma_f32_16x16x32_bf16 v[148:151], a[152:155], a[184:187], 0
  ds_read_b128 a[196:199], v34 offset:4096
  v_mfma_f32_16x16x32_bf16 v[152:155], a[152:155], a[188:191], 0
  buffer_load_dwordx4 v3, s[16:19], s35 offen offset:1024 lds
  v_mfma_f32_16x16x32_bf16 v[156:159], a[152:155], a[192:195], 0
  s_waitcnt lgkmcnt(1)
  v_mfma_f32_16x16x32_bf16 v[160:163], a[156:159], a[180:183], 0
  ds_read_b64_tr_b16 a[148:149], v26
  v_mfma_f32_16x16x32_bf16 v[164:167], a[156:159], a[184:187], 0
  ds_read_b64_tr_b16 a[150:151], v26 offset:4096
  v_mfma_f32_16x16x32_bf16 v[168:171], a[156:159], a[188:191], 0
  buffer_load_dwordx4 v4, s[16:19], s35 offen offset:2048 lds
  v_mfma_f32_16x16x32_bf16 v[172:175], a[156:159], a[192:195], 0
  ds_read_b64_tr_b16 a[152:153], v27
  v_mfma_f32_16x16x32_bf16 v[176:179], a[160:163], a[180:183], 0
  ds_read_b64_tr_b16 a[154:155], v27 offset:4096
  v_mfma_f32_16x16x32_bf16 v[180:183], a[160:163], a[184:187], 0
  ds_read_b128 a[200:203], v34 offset:5120
  v_mfma_f32_16x16x32_bf16 v[184:187], a[160:163], a[188:191], 0
  buffer_load_dwordx4 v5, s[16:19], s35 offen offset:3072 lds
  v_mfma_f32_16x16x32_bf16 v[188:191], a[160:163], a[192:195], 0
  s_waitcnt lgkmcnt(1)
  v_mfma_f32_16x16x32_bf16 v[192:195], a[148:151], a[180:183], 0
  ds_read_b64_tr_b16 a[156:157], v28
  v_mfma_f32_16x16x32_bf16 v[196:199], a[148:151], a[184:187], 0
  ds_read_b64_tr_b16 a[158:159], v28 offset:4096
  s_add_u32 m0, s33, 0x5000
  v_mfma_f32_16x16x32_bf16 v[200:203], a[148:151], a[188:191], 0
  buffer_load_dwordx4 v6, s[16:19], s35 offen lds
  v_mfma_f32_16x16x32_bf16 v[204:207], a[148:151], a[192:195], 0
  ds_read_b64_tr_b16 a[160:161], v29
  v_mfma_f32_16x16x32_bf16 v[208:211], a[152:155], a[180:183], 0
  ds_read_b64_tr_b16 a[162:163], v29 offset:4096
  v_mfma_f32_16x16x32_bf16 v[212:215], a[152:155], a[184:187], 0
  ds_read_b128 a[204:207], v34 offset:6144
  v_mfma_f32_16x16x32_bf16 v[216:219], a[152:155], a[188:191], 0
  buffer_load_dwordx4 v7, s[16:19], s35 offen offset:1024 lds
  v_mfma_f32_16x16x32_bf16 v[220:223], a[152:155], a[192:195], 0
  s_waitcnt lgkmcnt(1)
  v_mfma_f32_16x16x32_bf16 v[224:227], a[156:159], a[180:183], 0
  s_waitcnt vmcnt(7)
  ds_read_b64_tr_b16 a[148:149], v22 offset:8192
  v_mfma_f32_16x16x32_bf16 v[228:231], a[156:159], a[184:187], 0
  ds_read_b64_tr_b16 a[150:151], v22 offset:12288
  v_mfma_f32_16x16x32_bf16 v[232:235], a[156:159], a[188:191], 0
  buffer_load_dwordx4 v8, s[16:19], s35 offen offset:2048 lds
  v_mfma_f32_16x16x32_bf16 v[236:239], a[156:159], a[192:195], 0
  ds_read_b64_tr_b16 a[152:153], v23 offset:8192
  v_mfma_f32_16x16x32_bf16 v[240:243], a[160:163], a[180:183], 0
  ds_read_b64_tr_b16 a[154:155], v23 offset:12288
  v_mfma_f32_16x16x32_bf16 v[244:247], a[160:163], a[184:187], 0
  buffer_load_dwordx4 v9, s[16:19], s35 offen offset:3072 lds
  v_mfma_f32_16x16x32_bf16 v[248:251], a[160:163], a[188:191], 0
  ds_read_b128 a[208:211], v34 offset:7168
  s_add_u32 s35, s35, 0x8000
  v_mfma_f32_16x16x32_bf16 v[252:255], a[160:163], a[192:195], 0
  s_and_b32 s35, s35, 0x7ffff
  s_mov_b32 s38, 4
L_go_3:
  s_waitcnt lgkmcnt(0)
  v_mfma_f32_16x16x32_bf16 v[128:131], a[148:151], a[196:199], v[128:131]
  ds_read_b64_tr_b16 a[156:157], v24 offset:8192
  v_mfma_f32_16x16x32_bf16 v[132:135], a[148:151], a[200:203], v[132:135]
  ds_read_b64_tr_b16 a[158:159], v24 offset:12288
  s_add_u32 m0, s33, 0
  v_mfma_f32_16x16x32_bf16 v[136:139], a[148:151], a[204:207], v[136:139]
  buffer_load_dwordx4 v2, s[16:19], s35 offen lds
  v_mfma_f32_16x16x32_bf16 v[140:143], a[148:151], a[208:211], v[140:143]
  ds_read_b64_tr_b16 a[160:161], v25 offset:8192
  v_mfma_f32_16x16x32_bf16 v[144:147], a[152:155], a[196:199], v[144:147]
  ds_read_b64_tr_b16 a[162:163], v25 offset:12288
  v_mfma_f32_16x16x32_bf16 v[148:151], a[152:155], a[200:203], v[148:151]
  ds_read_b128 a[212:215], v34 offset:8192
  v_mfma_f32_16x16x32_bf16 v[152:155], a[152:155], a[204:207], v[152:155]
  buffer_load_dwordx4 v3, s[16:19], s35 offen offset:1024 lds
  v_mfma_f32_16x16x32_bf16 v[156:159], a[152:155], a[208:211], v[156:159]
  s_waitcnt lgkmcnt(1)
  v_mfma_f32_16x16x32_bf16 v[160:163], a[156:159], a[196:199], v[160:163]
  ds_read_b64_tr_b16 a[148:149], v26 offset:8192
  v_mfma_f32_16x16x32_bf16 v[164:167], a[156:159], a[200:203], v[164:167]
  ds_read_b64_tr_b16 a[150:151], v26 offset:12288
  v_mfma_f32_16x16x32_bf16 v[168:171], a[156:159], a[204:207], v[168:171]
  buffer_load_dwordx4 v4, s[16:19], s35 offen offset:2048 lds
  v_mfma_f32_16x16x32_bf16 v[172:175], a[156:159], a[208:211], v[172:175]
  ds_read_b64_tr_b16 a[152:153], v27 offset:8192
  v_mfma_f32_16x16x32_bf16 v[176:179], a[160:163], a[196:199], v[176:179]
  ds_read_b64_tr_b16 a[154:155], v27 offset:12288
  v_mfma_f32_16x16x32_bf16 v[180:183], a[160:163], a[200:203], v[180:183]
  ds_read_b128 a[216:219], v34 offset:9216
  v_mfma_f32_16x16x32_bf16 v[184:187], a[160:163], a[204:207], v[184:187]
  buffer_load_dwordx4 v5, s[16:19], s35 offen offset:3072 lds
  v_mfma_f32_16x16x32_bf16 v[188:191], a[160:163], a[208:211], v[188:191]
  s_waitcnt lgkmcnt(1)
  v_mfma_f32_16x16x32_bf16 v[192:195], a[148:151], a[196:199], v[192:195]
  ds_read_b64_tr_b16 a[156:157], v28 offset:8192
  v_mfma_f32_16x16x32_bf16 v[196:199], a[148:151], a[200:203], v[196:199]
  ds_read_b64_tr_b16 a[158:159], v28 offset:12288
  s_add_u32 m0, s33, 0x1000
  v_mfma_f32_16x16x32_bf16 v[200:203], a[148:151], a[204:207], v[200:203]
  buffer_load_dwordx4 v6, s[16:19], s35 offen lds
  v_mfma_f32_16x16x32_bf16 v[204:207], a[148:151], a[208:211], v[204:207]
  ds_read_b64_tr_b16 a[160:161], v29 offset:8192
  v_mfma_f32_16x16x32_bf16 v[208:211], a[152:155], a[196:199], v[208:211]
  ds_read_b64_tr_b16 a[162:163], v29 offset:12288
  v_mfma_f32_16x16x32_bf16 v[212:215], a[152:155], a[200:203], v[212:215]
  ds_read_b128 a[220:223], v34 offset:10240
  v_mfma_f32_16x16x32_bf16 v[216:219], a[152:155], a[204:207], v[216:219]
  buffer_load_dwordx4 v7, s[16:19], s35 offen offset:1024 lds
  v_mfma_f32_16x16x32_bf16 v[220:223], a[152:155], a[208:211], v[220:223]
  s_waitcnt lgkmcnt(1)
  v_mfma_f32_16x16x32_bf16 v[224:227], a[156:159], a[196:199], v[224:227]
  s_waitcnt vmcnt(6)
  ds_read_b64_tr_b16 a[148:149], v22 offset:16384
  v_mfma_f32_16x16x32_bf16 v[228:231], a[156:159], a[200:203], v[228:231]
  ds_read_b64_tr_b16 a[150:151], v22 offset:20480
  v_mfma_f32_16x16x32_bf16 v[232:235], a[156:159], a[204:207], v[232:235]
  buffer_load_dwordx4 v8, s[16:19], s35 offen offset:2048 lds
  v_mfma_f32_16x16x32_bf16 v[236:239], a[156:159], a[208:211], v[236:239]
  ds_read_b64_tr_b16 a[152:153], v23 offset:16384
  v_mfma_f32_16x16x32_bf16 v[240:243], a[160:163], a[196:199], v[240:243]
  ds_read_b64_tr_b16 a[154:155], v23 offset:20480
  v_mfma_f32_16x16x32_bf16 v[244:247], a[160:163], a[200:203], v[244:247]
  buffer_load_dwordx4 v9, s[16:19], s35 offen offset:3072 lds
  v_mfma_f32_16x16x32_bf16 v[248:251], a[160:163], a[204:207], v[248:251]
  ds_read_b128 a[224:227], v34 offset:11264
  s_add_u32 s35, s35, 0x8000
  v_mfma_f32_16x16x32_bf16 v[252:255], a[160:163], a[208:211], v[252:255]
  s_and_b32 s35, s35, 0x7ffff
  s_waitcnt lgkmcnt(0)
  v_mfma_f32_16x16x32_bf16 v[128:131], a[148:151], a[212:215], v[128:131]
  ds_read_b64_tr_b16 a[156:157], v24 offset:16384
  v_mfma_f32_16x16x32_bf16 v[132:135], a[148:151], a[216:219], v[132:135]
  ds_read_b64_tr_b16 a[158:159], v24 offset:20480
  s_add_u32 m0, s33, 0x2000
  v_mfma_f32_16x16x32_bf16 v[136:139], a[148:151], a[220:223], v[136:139]
  buffer_load_dwordx4 v2, s[16:19], s35 offen lds
  v_mfma_f32_16x16x32_bf16 v[140:143], a[148:151], a[224:227], v[140:143]
  ds_read_b64_tr_b16 a[160:161], v25 offset:16384
  v_mfma_f32_16x16x32_bf16 v[144:147], a[152:155], a[212:215], v[144:147]
  ds_read_b64_tr_b16 a[162:163], v25 offset:20480
  v_mfma_f32_16x16x32_bf16 v[148:151], a[152:155], a[216:219], v[148:151]
  ds_read_b128 a[180:183], v34 offset:12288
  v_mfma_f32_16x16x32_bf16 v[152:155], a[152:155], a[220:223], v[152:155]
  buffer_load_dwordx4 v3, s[16:19], s35 offen offset:1024 lds
  v_mfma_f32_16x16x32_bf16 v[156:159], a[152:155], a[224:227], v[156:159]
  s_waitcnt lgkmcnt(1)
  v_mfma_f32_16x16x32_bf16 v[160:163], a[156:159], a[212:215], v[160:163]
  ds_read_b64_tr_b16 a[148:149], v26 offset:16384
  v_mfma_f32_16x16x32_bf16 v[164:167], a[156:159], a[216:219], v[164:167]
  ds_read_b64_tr_b16 a[150:151], v26 offset:20480
  v_mfma_f32_16x16x32_bf16 v[168:171], a[156:159], a[220:223], v[168:171]
  buffer_load_dwordx4 v4, s[16:19], s35 offen offset:2048 lds
  v_mfma_f32_16x16x32_bf16 v[172:175], a[156:159], a[224:227], v[172:175]
  ds_read_b64_tr_b16 a[152:153], v27 offset:16384
  v_mfma_f32_16x16x32_bf16 v[176:179], a[160:163], a[212:215], v[176:179]
  ds_read_b64_tr_b16 a[154:155], v27 offset:20480
  v_mfma_f32_16x16x32_bf16 v[180:183], a[160:163], a[216:219], v[180:183]
  ds_read_b128 a[184:187], v34 offset:13312
  v_mfma_f32_16x16x32_bf16 v[184:187], a[160:163], a[220:223], v[184:187]
  buffer_load_dwordx4 v5, s[16:19], s35 offen offset:3072 lds
  v_mfma_f32_16x16x32_bf16 v[188:191], a[160:163], a[224:227], v[188:191]
  s_waitcnt lgkmcnt(1)
  v_mfma_f32_16x16x32_bf16 v[192:195], a[148:151], a[212:215], v[192:195]
  ds_read_b64_tr_b16 a[156:157], v28 offset:16384
  v_mfma_f32_16x16x32_bf16 v[196:199], a[148:151], a[216:219], v[196:199]
  ds_read_b64_tr_b16 a[158:159], v28 offset:20480
  s_add_u32 m0, s33, 0x3000
  v_mfma_f32_16x16x32_bf16 v[200:203], a[148:151], a[220:223], v[200:203]
  buffer_load_dwordx4 v6, s[16:19], s35 offen lds
  v_mfma_f32_16x16x32_bf16 v[204:207], a[148:151], a[224:227], v[204:207]
  ds_read_b64_tr_b16 a[160:161], v29 offset:16384
  v_mfma_f32_16x16x32_bf16 v[208:211], a[152:155], a[212:215], v[208:211]
  ds_read_b64_tr_b16 a[162:163], v29 offset:20480
  v_mfma_f32_16x16x32_bf16 v[212:215], a[152:155], a[216:219], v[212:215]
  ds_read_b128 a[188:191], v34 offset:14336
  v_mfma_f32_16x16x32_bf16 v[216:219], a[152:155], a[220:223], v[216:219]
  buffer_load_dwordx4 v7, s[16:19], s35 offen offset:1024 lds
  v_mfma_f32_16x16x32_bf16 v[220:223], a[152:155], a[224:227], v[220:223]
  s_waitcnt lgkmcnt(1)
  v_mfma_f32_16x16x32_bf16 v[224:227], a[156:159], a[212:215], v[224:227]
  s_waitcnt vmcnt(6)
  ds_read_b64_tr_b16 a[148:149], v22
  v_mfma_f32_16x16x32_bf16 v[228:231], a[156:159], a[216:219], v[228:231]
  ds_read_b64_tr_b16 a[150:151], v22 offset:4096
  v_mfma_f32_16x16x32_bf16 v[232:235], a[156:159], a[220:223], v[232:235]
  buffer_load_dwordx4 v8, s[16:19], s35 offen offset:2048 lds
  v_mfma_f32_16x16x32_bf16 v[236:239], a[156:159], a[224:227], v[236:239]
  ds_read_b64_tr_b16 a[152:153], v23
  v_mfma_f32_16x16x32_bf16 v[240:243], a[160:163], a[212:215], v[240:243]
  ds_read_b64_tr_b16 a[154:155], v23 offset:4096
  v_mfma_f32_16x16x32_bf16 v[244:247], a[160:163], a[216:219], v[244:247]
  buffer_load_dwordx4 v9, s[16:19], s35 offen offset:3072 lds
  v_mfma_f32_16x16x32_bf16 v[248:251], a[160:163], a[220:223], v[248:251]
  ds_read_b128 a[192:195], v34 offset:15360
  s_add_u32 s35, s35, 0x8000
  v_mfma_f32_16x16x32_bf16 v[252:255], a[160:163], a[224:227], v[252:255]
  s_and_b32 s35, s35, 0x7ffff
  s_waitcnt lgkmcnt(0)
  v_mfma_f32_16x16x32_bf16 v[128:131], a[148:151], a[180:183], v[128:131]
  ds_read_b64_tr_b16 a[156:157], v24
  v_mfma_f32_16x16x32_bf16 v[132:135], a[148:151], a[184:187], v[132:135]
  ds_read_b64_tr_b16 a[158:159], v24 offset:4096
  s_add_u32 m0, s33, 0x4000
  v_mfma_f32_16x16x32_bf16 v[136:139], a[148:151], a[188:191], v[136:139]
  buffer_load_dwordx4 v2, s[16:19], s35 offen lds
  v_mfma_f32_16x16x32_bf16 v[140:143], a[148:151], a[192:195], v[140:143]
  ds_read_b64_tr_b16 a[160:161], v25
  v_mfma_f32_16x16x32_bf16 v[144:147], a[152:155], a[180:183], v[144:147]
  ds_read_b64_tr_b16 a[162:163], v25 offset:4096
  v_mfma_f32_16x16x32_bf16 v[148:151], a[152:155], a[184:187], v[148:151]
  ds_read_b128 a[196:199], v34 offset:16384
  v_mfma_f32_16x16x32_bf16 v[152:155], a[152:155], a[188:191], v[152:155]
  buffer_load_dwordx4 v3, s[16:19], s35 offen offset:1024 lds
  v_mfma_f32_16x16x32_bf16 v[156:159], a[152:155], a[192:195], v[156:159]
  s_waitcnt lgkmcnt(1)
  v_mfma_f32_16x16x32_bf16 v[160:163], a[156:159], a[180:183], v[160:163]
  ds_read_b64_tr_b16 a[148:149], v26
  v_mfma_f32_16x16x32_bf16 v[164:167], a[156:159], a[184:187], v[164:167]
  ds_read_b64_tr_b16 a[150:151], v26 offset:4096
  v_mfma_f32_16x16x32_bf16 v[168:171], a[156:159], a[188:191], v[168:171]
  buffer_load_dwordx4 v4, s[16:19], s35 offen offset:2048 lds
  v_mfma_f32_16x16x32_bf16 v[172:175], a[156:159], a[192:195], v[172:175]
  ds_read_b64_tr_b16 a[152:153], v27
  v_mfma_f32_16x16x32_bf16 v[176:179], a[160:163], a[180:183], v[176:179]
  ds_read_b64_tr_b16 a[154:155], v27 offset:4096
  v_mfma_f32_16x16x32_bf16 v[180:183], a[160:163], a[184:187], v[180:183]
  ds_read_b128 a[200:203], v34 offset:17408
  v_mfma_f32_16x16x32_bf16 v[184:187], a[160:163], a[188:191], v[184:187]
  buffer_load_dwordx4 v5, s[16:19], s35 offen offset:3072 lds
  v_mfma_f32_16x16x32_bf16 v[188:191], a[160:163], a[192:195], v[188:191]
  s_waitcnt lgkmcnt(1)
  v_mfma_f32_16x16x32_bf16 v[192:195], a[148:151], a[180:183], v[192:195]
  ds_read_b64_tr_b16 a[156:157], v28
  v_mfma_f32_16x16x32_bf16 v[196:199], a[148:151], a[184:187], v[196:199]
  ds_read_b64_tr_b16 a[158:159], v28 offset:4096
  s_add_u32 m0, s33, 0x5000
  v_mfma_f32_16x16x32_bf16 v[200:203], a[148:151], a[188:191], v[200:203]
  buffer_load_dwordx4 v6, s[16:19], s35 offen lds
  v_mfma_f32_16x16x32_bf16 v[204:207], a[148:151], a[192:195], v[204:207]
  ds_read_b64_tr_b16 a[160:161], v29
  v_mfma_f32_16x16x32_bf16 v[208:211], a[152:155], a[180:183], v[208:211]
  ds_read_b64_tr_b16 a[162:163], v29 offset:4096
  v_mfma_f32_16x16x32_bf16 v[212:215], a[152:155], a[184:187], v[212:215]
  ds_read_b128 a[204:207], v34 offset:18432
  v_mfma_f32_16x16x32_bf16 v[216:219], a[152:155], a[188:191], v[216:219]
  buffer_load_dwordx4 v7, s[16:19], s35 offen offset:1024 lds
  v_mfma_f32_16x16x32_bf16 v[220:223], a[152:155], a[192:195], v[220:223]
  s_waitcnt lgkmcnt(1)
  v_mfma_f32_16x16x32_bf16 v[224:227], a[156:159], a[180:183], v[224:227]
  s_waitcnt vmcnt(6)
  ds_read_b64_tr_b16 a[148:149], v22 offset:8192
  v_mfma_f32_16x16x32_bf16 v[228:231], a[156:159], a[184:187], v[228:231]
  ds_read_b64_tr_b16 a[150:151], v22 offset:12288
  v_mfma_f32_16x16x32_bf16 v[232:235], a[156:159], a[188:191], v[232:235]
  buffer_load_dwordx4 v8, s[16:19], s35 offen offset:2048 lds
  v_mfma_f32_16x16x32_bf16 v[236:239], a[156:159], a[192:195], v[236:239]
  ds_read_b64_tr_b16 a[152:153], v23 offset:8192
  v_mfma_f32_16x16x32_bf16 v[240:243], a[160:163], a[180:183], v[240:243]
  ds_read_b64_tr_b16 a[154:155], v23 offset:12288
  v_mfma_f32_16x16x32_bf16 v[244:247], a[160:163], a[184:187], v[244:247]
  buffer_load_dwordx4 v9, s[16:19], s35 offen offset:3072 lds
  v_mfma_f32_16x16x32_bf16 v[248:251], a[160:163], a[188:191], v[248:251]
  ds_read_b128 a[208:211], v34 offset:19456
  s_add_u32 s35, s35, 0x8000
  v_mfma_f32_16x16x32_bf16 v[252:255], a[160:163], a[192:195], v[252:255]
  s_and_b32 s35, s35, 0x7ffff
  v_add_u32 v34, 0x3000, v34
  s_sub_u32 s38, s38, 1
  s_cmp_lg_u32 s38, 0
  s_cbranch_scc1 L_go_3
  s_waitcnt lgkmcnt(0)
  v_mfma_f32_16x16x32_bf16 v[128:131], a[148:151], a[196:199], v[128:131]
  ds_read_b64_tr_b16 a[156:157], v24 offset:8192
  v_mfma_f32_16x16x32_bf16 v[132:135], a[148:151], a[200:203], v[132:135]
  ds_read_b64_tr_b16 a[158:159], v24 offset:12288
  s_add_u32 m0, s33, 0
  v_mfma_f32_16x16x32_bf16 v[136:139], a[148:151], a[204:207], v[136:139]
  buffer_load_dwordx4 v2, s[16:19], s35 offen lds
  v_mfma_f32_16x16x32_bf16 v[140:143], a[148:151], a[208:211], v[140:143]
  ds_read_b64_tr_b16 a[160:161], v25 offset:8192
  v_mfma_f32_16x16x32_bf16 v[144:147], a[152:155], a[196:199], v[144:147]
  ds_read_b64_tr_b16 a[162:163], v25 offset:12288
  v_mfma_f32_16x16x32_bf16 v[148:151], a[152:155], a[200:203], v[148:151]
  ds_read_b128 a[212:215], v34 offset:8192
  v_mfma_f32_16x16x32_bf16 v[152:155], a[152:155], a[204:207], v[152:155]
  buffer_load_dwordx4 v3, s[16:19], s35 offen offset:1024 lds
  v_mfma_f32_16x16x32_bf16 v[156:159], a[152:155], a[208:211], v[156:159]
  s_waitcnt lgkmcnt(1)
  v_mfma_f32_16x16x32_bf16 v[160:163], a[156:159], a[196:199], v[160:163]
  ds_read_b64_tr_b16 a[148:149], v26 offset:8192
  v_mfma_f32_16x16x32_bf16 v[164:167], a[156:159], a[200:203], v[164:167]
  ds_read_b64_tr_b16 a[150:151], v26 offset:12288
  v_mfma_f32_16x16x32_bf16 v[168:171], a[156:159], a[204:207], v[168:171]
  buffer_load_dwordx4 v4, s[16:19], s35 offen offset:2048 lds
  v_mfma_f32_16x16x32_bf16 v[172:175], a[156:159], a[208:211], v[172:175]
  ds_read_b64_tr_b16 a[152:153], v27 offset:8192
  v_mfma_f32_16x16x32_bf16 v[176:179], a[160:163], a[196:199], v[176:179]
  ds_read_b64_tr_b16 a[154:155], v27 offset:12288
  v_mfma_f32_16x16x32_bf16 v[180:183], a[160:163], a[200:203], v[180:183]
  ds_read_b128 a[216:219], v34 offset:9216
  v_mfma_f32_16x16x32_bf16 v[184:187], a[160:163], a[204:207], v[184:187]
  buffer_load_dwordx4 v5, s[16:19], s35 offen offset:3072 lds
  v_mfma_f32_16x16x32_bf16 v[188:191], a[160:163], a[208:211], v[188:191]
  s_waitcnt lgkmcnt(1)
  v_mfma_f32_16x16x32_bf16 v[192:195], a[148:151], a[196:199], v[192:195]
  ds_read_b64_tr_b16 a[156:157], v28 offset:8192
  v_mfma_f32_16x16x32_bf16 v[196:199], a[148:151], a[200:203], v[196:199]
  ds_read_b64_tr_b16 a[158:159], v28 offset:12288
  s_add_u32 m0, s33, 0x1000
  v_mfma_f32_16x16x32_bf16 v[200:203], a[148:151], a[204:207], v[200:203]
  buffer_load_dwordx4 v6, s[16:19], s35 offen lds
  v_mfma_f32_16x16x32_bf16 v[204:207], a[148:151], a[208:211], v[204:207]
  ds_read_b64_tr_b16 a[160:161], v29 offset:8192
  v_mfma_f32_16x16x32_bf16 v[208:211], a[152:155], a[196:199], v[208:211]
  ds_read_b64_tr_b16 a[162:163], v29 offset:12288
  v_mfma_f32_16x16x32_bf16 v[212:215], a[152:155], a[200:203], v[212:215]
  ds_read_b128 a[220:223], v34 offset:10240
  v_mfma_f32_16x16x32_bf16 v[216:219], a[152:155], a[204:207], v[216:219]
  buffer_load_dwordx4 v7, s[16:19], s35 offen offset:1024 lds
  v_mfma_f32_16x16x32_bf16 v[220:223], a[152:155], a[208:211], v[220:223]
  s_waitcnt lgkmcnt(1)
  v_mfma_f32_16x16x32_bf16 v[224:227], a[156:159], a[196:199], v[224:227]
  s_waitcnt vmcnt(6)
  ds_read_b64_tr_b16 a[148:149], v22 offset:16384
  v_mfma_f32_16x16x32_bf16 v[228:231], a[156:159], a[200:203], v[228:231]
  ds_read_b64_tr_b16 a[150:151], v22 offset:20480
  v_mfma_f32_16x16x32_bf16 v[232:235], a[156:159], a[204:207], v[232:235]
  buffer_load_dwordx4 v8, s[16:19], s35 offen offset:2048 lds
  v_mfma_f32_16x16x32_bf16 v[236:239], a[156:159], a[208:211], v[236:239]
  ds_read_b64_tr_b16 a[152:153], v23 offset:16384
  v_mfma_f32_16x16x32_bf16 v[240:243], a[160:163], a[196:199], v[240:243]
  ds_read_b64_tr_b16 a[154:155], v23 offset:20480
  v_mfma_f32_16x16x32_bf16 v[244:247], a[160:163], a[200:203], v[244:247]
  buffer_load_dwordx4 v9, s[16:19], s35 offen offset:3072 lds
  v_mfma_f32_16x16x32_bf16 v[248:251], a[160:163], a[204:207], v[248:251]
  ds_read_b128 a[224:227], v34 offset:11264
  s_add_u32 s35, s35, 0x8000
  v_mfma_f32_16x16x32_bf16 v[252:255], a[160:163], a[208:211], v[252:255]
  s_and_b32 s35, s35, 0x7ffff
  s_waitcnt lgkmcnt(0)
  v_mfma_f32_16x16x32_bf16 v[128:131], a[148:151], a[212:215], v[128:131]
  ds_read_b64_tr_b16 a[156:157], v24 offset:16384
  v_mfma_f32_16x16x32_bf16 v[132:135], a[148:151], a[216:219], v[132:135]
  ds_read_b64_tr_b16 a[158:159], v24 offset:20480
  v_mfma_f32_16x16x32_bf16 v[136:139], a[148:151], a[220:223], v[136:139]
  v_mfma_f32_16x16x32_bf16 v[140:143], a[148:151], a[224:227], v[140:143]
  ds_read_b64_tr_b16 a[160:161], v25 offset:16384
  v_mfma_f32_16x16x32_bf16 v[144:147], a[152:155], a[212:215], v[144:147]
  ds_read_b64_tr_b16 a[162:163], v25 offset:20480
  v_mfma_f32_16x16x32_bf16 v[148:151], a[152:155], a[216:219], v[148:151]
  ds_read_b128 a[180:183], v34 offset:12288
  v_mfma_f32_16x16x32_bf16 v[152:155], a[152:155], a[220:223], v[152:155]
  v_mfma_f32_16x16x32_bf16 v[156:159], a[152:155], a[224:227], v[156:159]
  s_waitcnt lgkmcnt(1)
  v_mfma_f32_16x16x32_bf16 v[160:163], a[156:159], a[212:215], v[160:163]
  ds_read_b64_tr_b16 a[148:149], v26 offset:16384
  v_mfma_f32_16x16x32_bf16 v[164:167], a[156:159], a[216:219], v[164:167]
  ds_read_b64_tr_b16 a[150:151], v26 offset:20480
  v_mfma_f32_16x16x32_bf16 v[168:171], a[156:159], a[220:223], v[168:171]
  v_mfma_f32_16x16x32_bf16 v[172:175], a[156:159], a[224:227], v[172:175]
  ds_read_b64_tr_b16 a[152:153], v27 offset:16384
  v_mfma_f32_16x16x32_bf16 v[176:179], a[160:163], a[212:215], v[176:179]
  ds_read_b64_tr_b16 a[154:155], v27 offset:20480
  v_mfma_f32_16x16x32_bf16 v[180:183], a[160:163], a[216:219], v[180:183]
  ds_read_b128 a[184:187], v34 offset:13312
  v_mfma_f32_16x16x32_bf16 v[184:187], a[160:163], a[220:223], v[184:187]
  v_mfma_f32_16x16x32_bf16 v[188:191], a[160:163], a[224:227], v[188:191]
  s_waitcnt lgkmcnt(1)
  v_mfma_f32_16x16x32_bf16 v[192:195], a[148:151], a[212:215], v[192:195]
  ds_read_b64_tr_b16 a[156:157], v28 offset:16384
  v_mfma_f32_16x16x32_bf16 v[196:199], a[148:151], a[216:219], v[196:199]
  ds_read_b64_tr_b16 a[158:159], v28 offset:20480
  v_mfma_f32_16x16x32_bf16 v[200:203], a[148:151], a[220:223], v[200:203]
  v_mfma_f32_16x16x32_bf16 v[204:207], a[148:151], a[224:227], v[204:207]
  ds_read_b64_tr_b16 a[160:161], v29 offset:16384
  v_mfma_f32_16x16x32_bf16 v[208:211], a[152:155], a[212:215], v[208:211]
  ds_read_b64_tr_b16 a[162:163], v29 offset:20480
  v_mfma_f32_16x16x32_bf16 v[212:215], a[152:155], a[216:219], v[212:215]
  ds_read_b128 a[188:191], v34 offset:14336
  v_mfma_f32_16x16x32_bf16 v[216:219], a[152:155], a[220:223], v[216:219]
  v_mfma_f32_16x16x32_bf16 v[220:223], a[152:155], a[224:227], v[220:223]
  s_waitcnt lgkmcnt(1)
  v_mfma_f32_16x16x32_bf16 v[224:227], a[156:159], a[212:215], v[224:227]
  s_waitcnt vmcnt(0)
  ds_read_b64_tr_b16 a[148:149], v22
  v_mfma_f32_16x16x32_bf16 v[228:231], a[156:159], a[216:219], v[228:231]
  ds_read_b64_tr_b16 a[150:151], v22 offset:4096
  v_mfma_f32_16x16x32_bf16 v[232:235], a[156:159], a[220:223], v[232:235]
  v_mfma_f32_16x16x32_bf16 v[236:239], a[156:159], a[224:227], v[236:239]
  ds_read_b64_tr_b16 a[152:153], v23
  v_mfma_f32_16x16x32_bf16 v[240:243], a[160:163], a[212:215], v[240:243]
  ds_read_b64_tr_b16 a[154:155], v23 offset:4096
  v_mfma_f32_16x16x32_bf16 v[244:247], a[160:163], a[216:219], v[244:247]
  v_mfma_f32_16x16x32_bf16 v[248:251], a[160:163], a[220:223], v[248:251]
  ds_read_b128 a[192:195], v34 offset:15360
  v_mfma_f32_16x16x32_bf16 v[252:255], a[160:163], a[224:227], v[252:255]
  s_waitcnt lgkmcnt(0)
  v_mfma_f32_16x16x32_bf16 v[128:131], a[148:151], a[180:183], v[128:131]
  ds_read_b64_tr_b16 a[156:157], v24
  v_mfma_f32_16x16x32_bf16 v[132:135], a[148:151], a[184:187], v[132:135]
  ds_read_b64_tr_b16 a[158:159], v24 offset:4096
  v_mfma_f32_16x16x32_bf16 v[136:139], a[148:151], a[188:191], v[136:139]
  v_mfma_f32_16x16x32_bf16 v[140:143], a[148:151], a[192:195], v[140:143]
  ds_read_b64_tr_b16 a[160:161], v25
  v_mfma_f32_16x16x32_bf16 v[144:147], a[152:155], a[180:183], v[144:147]
  ds_read_b64_tr_b16 a[162:163], v25 offset:4096
  v_mfma_f32_16x16x32_bf16 v[148:151], a[152:155], a[184:187], v[148:151]
  v_mfma_f32_16x16x32_bf16 v[152:155], a[152:155], a[188:191], v[152:155]
  v_mfma_f32_16x16x32_bf16 v[156:159], a[152:155], a[192:195], v[156:159]
  v_cvt_pk_bf16_f32 v46, v128, v129
  v_cvt_pk_bf16_f32 v47, v130, v131
  s_nop 1
  v_cvt_pk_bf16_f32 v48, v144, v145
  v_cvt_pk_bf16_f32 v49, v146, v147
  s_waitcnt lgkmcnt(0)
  v_mfma_f32_16x16x32_bf16 v[160:163], a[156:159], a[180:183], v[160:163]
  ds_read_b64_tr_b16 a[148:149], v26
  buffer_store_dwordx4 v[46:49], v35, s[20:23], s45 offen sc1
  v_cvt_pk_bf16_f32 v50, v132, v133
  v_cvt_pk_bf16_f32 v51, v134, v135
  v_mfma_f32_16x16x32_bf16 v[164:167], a[156:159], a[184:187], v[164:167]
  ds_read_b64_tr_b16 a[150:151], v26 offset:4096
  v_cvt_pk_bf16_f32 v52, v148, v149
  v_cvt_pk_bf16_f32 v53, v150, v151
  buffer_store_dwordx4 v[50:53], v35, s[20:23], s45 offen offset:1024 sc1
  v_mfma_f32_16x16x32_bf16 v[168:171], a[156:159], a[188:191], v[168:171]
  v_cvt_pk_bf16_f32 v54, v136, v137
  v_cvt_pk_bf16_f32 v55, v138, v139
  v_cvt_pk_bf16_f32 v56, v152, v153
  v_cvt_pk_bf16_f32 v57, v154, v155
  v_mfma_f32_16x16x32_bf16 v[172:175], a[156:159], a[192:195], v[172:175]
  ds_read_b64_tr_b16 a[152:153], v27
  buffer_store_dwordx4 v[54:57], v35, s[20:23], s45 offen offset:2048 sc1
  v_cvt_pk_bf16_f32 v58, v140, v141
  v_cvt_pk_bf16_f32 v59, v142, v143
  v_mfma_f32_16x16x32_bf16 v[176:179], a[160:163], a[180:183], v[176:179]
  ds_read_b64_tr_b16 a[154:155], v27 offset:4096
  v_cvt_pk_bf16_f32 v60, v156, v157
  v_cvt_pk_bf16_f32 v61, v158, v159
  buffer_store_dwordx4 v[58:61], v35, s[20:23], s45 offen offset:3072 sc1
  v_mfma_f32_16x16x32_bf16 v[180:183], a[160:163], a[184:187], v[180:183]
  s_add_u32 s45, s45, 0x1000
  v_mfma_f32_16x16x32_bf16 v[184:187], a[160:163], a[188:191], v[184:187]
  v_mfma_f32_16x16x32_bf16 v[188:191], a[160:163], a[192:195], v[188:191]
  v_cvt_pk_bf16_f32 v46, v160, v161
  v_cvt_pk_bf16_f32 v47, v162, v163
  v_cvt_pk_bf16_f32 v48, v176, v177
  v_cvt_pk_bf16_f32 v49, v178, v179
  s_waitcnt lgkmcnt(0)
  v_mfma_f32_16x16x32_bf16 v[192:195], a[148:151], a[180:183], v[192:195]
  ds_read_b64_tr_b16 a[156:157], v28
  buffer_store_dwordx4 v[46:49], v35, s[20:23], s45 offen sc1
  v_cvt_pk_bf16_f32 v50, v164, v165
  v_cvt_pk_bf16_f32 v51, v166, v167
  v_mfma_f32_16x16x32_bf16 v[196:199], a[148:151], a[184:187], v[196:199]
  ds_read_b64_tr_b16 a[158:159], v28 offset:4096
  v_cvt_pk_bf16_f32 v52, v180, v181
  v_cvt_pk_bf16_f32 v53, v182, v183
  buffer_store_dwordx4 v[50:53], v35, s[20:23], s45 offen offset:1024 sc1
  v_mfma_f32_16x16x32_bf16 v[200:203], a[148:151], a[188:191], v[200:203]
  v_cvt_pk_bf16_f32 v54, v168, v169
  v_cvt_pk_bf16_f32 v55, v170, v171
  v_cvt_pk_bf16_f32 v56, v184, v185
  v_cvt_pk_bf16_f32 v57, v186, v187
  v_mfma_f32_16x16x32_bf16 v[204:207], a[148:151], a[192:195], v[204:207]
  ds_read_b64_tr_b16 a[160:161], v29
  buffer_store_dwordx4 v[54:57], v35, s[20:23], s45 offen offset:2048 sc1
  v_cvt_pk_bf16_f32 v58, v172, v173
  v_cvt_pk_bf16_f32 v59, v174, v175
  v_mfma_f32_16x16x32_bf16 v[208:211], a[152:155], a[180:183], v[208:211]
  ds_read_b64_tr_b16 a[162:163], v29 offset:4096
  v_cvt_pk_bf16_f32 v60, v188, v189
  v_cvt_pk_bf16_f32 v61, v190, v191
  buffer_store_dwordx4 v[58:61], v35, s[20:23], s45 offen offset:3072 sc1
  v_mfma_f32_16x16x32_bf16 v[212:215], a[152:155], a[184:187], v[212:215]
  s_add_u32 s45, s45, 0x1000
  v_mfma_f32_16x16x32_bf16 v[216:219], a[152:155], a[188:191], v[216:219]
  v_mfma_f32_16x16x32_bf16 v[220:223], a[152:155], a[192:195], v[220:223]
  v_cvt_pk_bf16_f32 v46, v192, v193
  v_cvt_pk_bf16_f32 v47, v194, v195
  v_cvt_pk_bf16_f32 v48, v208, v209
  v_cvt_pk_bf16_f32 v49, v210, v211
  s_waitcnt lgkmcnt(0)
  v_mfma_f32_16x16x32_bf16 v[224:227], a[156:159], a[180:183], v[224:227]
  buffer_store_dwordx4 v[46:49], v35, s[20:23], s45 offen sc1
  v_cvt_pk_bf16_f32 v50, v196, v197
  v_cvt_pk_bf16_f32 v51, v198, v199
  v_cvt_pk_bf16_f32 v52, v212, v213
  v_mfma_f32_16x16x32_bf16 v[228:231], a[156:159], a[184:187], v[228:231]
  v_cvt_pk_bf16_f32 v53, v214, v215
  buffer_store_dwordx4 v[50:53], v35, s[20:23], s45 offen offset:1024 sc1
  v_cvt_pk_bf16_f32 v54, v200, v201
  v_cvt_pk_bf16_f32 v55, v202, v203
  v_mfma_f32_16x16x32_bf16 v[232:235], a[156:159], a[188:191], v[232:235]
  v_cvt_pk_bf16_f32 v56, v216, v217
  v_cvt_pk_bf16_f32 v57, v218, v219
  buffer_store_dwordx4 v[54:57], v35, s[20:23], s45 offen offset:2048 sc1
  v_cvt_pk_bf16_f32 v58, v204, v205
  v_mfma_f32_16x16x32_bf16 v[236:239], a[156:159], a[192:195], v[236:239]
  v_cvt_pk_bf16_f32 v59, v206, v207
  v_cvt_pk_bf16_f32 v60, v220, v221
  v_cvt_pk_bf16_f32 v61, v222, v223
  buffer_store_dwordx4 v[58:61], v35, s[20:23], s45 offen offset:3072 sc1
  v_mfma_f32_16x16x32_bf16 v[240:243], a[160:163], a[180:183], v[240:243]
  s_add_u32 s45, s45, 0x1000
  v_mfma_f32_16x16x32_bf16 v[244:247], a[160:163], a[184:187], v[244:247]
  v_mfma_f32_16x16x32_bf16 v[248:251], a[160:163], a[188:191], v[248:251]
  v_mfma_f32_16x16x32_bf16 v[252:255], a[160:163], a[192:195], v[252:255]
  v_cvt_pk_bf16_f32 v46, v224, v225
  v_cvt_pk_bf16_f32 v47, v226, v227
  s_nop 1
  v_cvt_pk_bf16_f32 v48, v240, v241
  v_cvt_pk_bf16_f32 v49, v242, v243
  buffer_store_dwordx4 v[46:49], v35, s[20:23], s45 offen sc1
  v_cvt_pk_bf16_f32 v50, v228, v229
  v_cvt_pk_bf16_f32 v51, v230, v231
  v_cvt_pk_bf16_f32 v52, v244, v245
  v_cvt_pk_bf16_f32 v53, v246, v247
  buffer_store_dwordx4 v[50:53], v35, s[20:23], s45 offen offset:1024 sc1
  v_cvt_pk_bf16_f32 v54, v232, v233
  v_cvt_pk_bf16_f32 v55, v234, v235
  v_cvt_pk_bf16_f32 v56, v248, v249
  v_cvt_pk_bf16_f32 v57, v250, v251
  buffer_store_dwordx4 v[54:57], v35, s[20:23], s45 offen offset:2048 sc1
  v_cvt_pk_bf16_f32 v58, v236, v237
  v_cvt_pk_bf16_f32 v59, v238, v239
  v_cvt_pk_bf16_f32 v60, v252, v253
  v_cvt_pk_bf16_f32 v61, v254, v255
  buffer_store_dwordx4 v[58:61], v35, s[20:23], s45 offen offset:3072 sc1
  s_nop 0
  s_nop 0
  s_nop 0
  v_subrev_u32 v34, 0xc000, v34
  s_mov_b32 s4, s82
  s_mov_b32 s5, s83
  s_mov_b32 s6, 0x158000
  s_mov_b32 s7, 0x20000
  s_mov_b32 s8, s84
  s_mov_b32 s9, s85
  s_mov_b32 s10, 0x158000
  s_mov_b32 s11, 0x20000
  s_mov_b32 s12, s86
  s_mov_b32 s13, s87
  s_mov_b32 s14, 0x158000
  s_mov_b32 s15, 0x20000
  s_mov_b32 s16, s88
  s_mov_b32 s17, s89
  s_mov_b32 s18, 0x200000
  s_mov_b32 s19, 0x20000
  s_and_b32 s39, s29, 1
  s_lshl_b32 s39, s39, 2
  s_and_b32 s40, s30, 3
  s_add_u32 s52, s39, s40
  s_lshr_b32 s39, s29, 1
  s_mul_i32 s40, s39, 7
  s_add_u32 s40, s40, 1
  s_cmp_eq_u32 s39, 0
  s_cselect_b32 s53, 0, s40
  s_cselect_b32 s39, 8, 7
  s_lshr_b32 s40, s30, 2
  s_add_u32 s53, s53, s40
  s_cmp_lt_u32 s40, s39
  s_cselect_b32 s54, 1, 0
  s_lshl_b32 s91, s40, 1
  v_and_b32 v3, 7, v1
  v_lshrrev_b32 v2, 3, v1
  v_and_b32 v2, 3, v2
  v_lshrrev_b32 v4, 5, v1
  s_lshr_b32 s66, s29, 1
  s_and_b32 s67, s29, 1
  v_lshlrev_b32 v5, 4, v2
  v_add_u32 v5, v5, v3
  s_lshl_b32 s39, s67, 3
  v_add_u32 v5, s39, v5
  v_lshlrev_b32 v5, 4, v5
  v_lshlrev_b32 v6, 12, v4
  v_add_u32 v8, v5, v6
  s_mul_i32 s68, s30, 0x11000
  s_lshl_b32 s39, s28, 14
  s_add_u32 s68, s68, s39
  s_lshl_b32 s39, s66, 10
  s_add_u32 s68, s68, s39
  s_add_u32 s68, s68, 0xb84000
  v_accvgpr_read_b32 v62, a248
  s_nop 0
  v_readfirstlane_b32 s50, v62
  s_nop 3
  s_cmp_ge_u32 s50, 64
  s_cbranch_scc1 C_mod1_ok
  s_mov_b32 s51, 0
W_mod1:
  buffer_load_dword v62, v63, s[96:99], 0 offen offset:8 sc1
  s_waitcnt vmcnt(0)
  v_readfirstlane_b32 s50, v62
  s_nop 3
  s_cmp_ge_u32 s50, 64
  s_cbranch_scc1 W_mod1_done
  s_add_u32 s51, s51, 1
  s_cmp_lt_u32 s51, 0x40000
  s_sleep 1
  s_cbranch_scc1 W_mod1
W_mod1_done:
C_mod1_ok:
  s_lshl_b32 s39, s30, 6
  s_lshl_b32 s40, s66, 4
  s_add_u32 s39, s39, s40
  s_lshl_b32 s40, s67, 3
  s_add_u32 s39, s39, s40
  v_add_u32 v5, s39, v3
  v_lshlrev_b32 v5, 10, v5
  v_lshlrev_b32 v6, 6, v4
  v_lshlrev_b32 v7, 3, v2
  v_add3_u32 v9, v5, v6, v7
  s_lshl_b32 s39, s28, 8
  buffer_load_dwordx2 v[12:13], v9, s[24:27], s39 offen
  buffer_load_dwordx2 v[14:15], v9, s[24:27], s39 offen offset:32
  buffer_load_dwordx2 v[16:17], v9, s[24:27], s39 offen offset:128
  buffer_load_dwordx2 v[18:19], v9, s[24:27], s39 offen offset:160
  v_lshlrev_b32 v6, 7, v4
  v_lshlrev_b32 v7, 4, v2
  v_add_u32 v10, v6, v7
  s_lshl_b32 s39, s28, 9
  s_add_u32 s40, s39, 0x1000
  buffer_load_dwordx4 v[160:163], v10, s[20:23], s40 offen sc1
  buffer_load_dwordx4 v[164:167], v10, s[20:23], s40 offen offset:64 sc1
  buffer_load_dwordx4 v[168:171], v10, s[20:23], s40 offen offset:256 sc1
  buffer_load_dwordx4 v[172:175], v10, s[20:23], s40 offen offset:320 sc1
  s_add_u32 s40, s39, 0x1800
  buffer_load_dwordx4 v[176:179], v10, s[20:23], s40 offen sc1
  buffer_load_dwordx4 v[180:183], v10, s[20:23], s40 offen offset:64 sc1
  buffer_load_dwordx4 v[184:187], v10, s[20:23], s40 offen offset:256 sc1
  buffer_load_dwordx4 v[188:191], v10, s[20:23], s40 offen offset:320 sc1
  s_lshl_b32 s39, s28, 9
  s_add_u32 s40, s39, 0x2000
  buffer_load_dwordx4 v[192:195], v10, s[20:23], s40 offen sc1
  buffer_load_dwordx4 v[196:199], v10, s[20:23], s40 offen offset:64 sc1
  buffer_load_dwordx4 v[200:203], v10, s[20:23], s40 offen offset:256 sc1
  buffer_load_dwordx4 v[204:207], v10, s[20:23], s40 offen offset:320 sc1
  v_and_b32 v5, 15, v1
  v_lshrrev_b32 v6, 2, v5
  v_lshrrev_b32 v7, 4, v1
  v_cmp_eq_u32 vcc, v6, v7
  v_mov_b32 v6, 0x3f80
  s_nop 0
  v_cndmask_b32 v6, 0, v6, vcc
  v_and_b32 v7, 1, v5
  v_lshlrev_b32 v7, 4, v7
  v_lshlrev_b32 v6, v7, v6
  v_and_b32 v5, 2, v5
  v_cmp_eq_u32 vcc, 0, v5
  v_mov_b32 v208, 0
  v_mov_b32 v209, 0
  v_mov_b32 v212, 0
  v_mov_b32 v213, 0
  v_cndmask_b32 v210, 0, v6, vcc
  v_sub_u32 v211, v6, v210
  s_waitcnt vmcnt(0)
  s_cmp_lg_u32 s28, 0
  s_cbranch_scc1 S_part_pre
S_part_pre:
  s_barrier
  s_cmp_lg_u32 s28, 0
  s_cbranch_scc1 S_part_done
  v_mov_b32 v62, s90
  v_mov_b32 v63, 0
  s_lshl_b32 s50, s2, 7
  s_add_u32 s50, s50, 0x2000000
  s_mov_b64 exec, 1
  buffer_store_dword v62, v63, s[20:23], s50 offen sc1
  s_mov_b64 exec, -1
S_part_done:
  s_cmp_eq_u32 s54, 0
  s_cbranch_scc1 M_no_dw_early
  s_cmp_eq_u32 s28, 0
  s_cbranch_scc1 M_dw_done
  s_mov_b32 s61, 0xaaab
  s_mov_b32 s39, 0xac0
  v_add_u32 v216, 0, v1
  v_mul_lo_u32 v217, v216, s61
  v_lshrrev_b32 v217, 18, v217
  v_mul_u32_u24 v218, 6, v217
  v_sub_u32 v218, v216, v218
  v_lshlrev_b32 v218, 4, v218
  v_mul_lo_u32 v217, v217, s39
  v_add_u32 v224, v217, v218
  v_add_u32 v216, 64, v1
  v_mul_lo_u32 v217, v216, s61
  v_lshrrev_b32 v217, 18, v217
  v_mul_u32_u24 v218, 6, v217
  v_sub_u32 v218, v216, v218
  v_lshlrev_b32 v218, 4, v218
  v_mul_lo_u32 v217, v217, s39
  v_add_u32 v225, v217, v218
  v_subrev_u32 v225, 0x400, v225
  v_add_u32 v216, 0x80, v1
  v_mul_lo_u32 v217, v216, s61
  v_lshrrev_b32 v217, 18, v217
  v_mul_u32_u24 v218, 6, v217
  v_sub_u32 v218, v216, v218
  v_lshlrev_b32 v218, 4, v218
  v_mul_lo_u32 v217, v217, s39
  v_add_u32 v226, v217, v218
  v_subrev_u32 v226, 0x800, v226
  s_mul_i32 s63, s53, 0x60
  s_sub_u32 s62, s28, 1
M_dw_loop:
  s_add_u32 s39, s62, s91
  s_and_b32 s39, s39, 15
  s_mul_i32 s39, s39, 0x15800
  s_add_u32 s39, s39, s63
  s_mul_i32 s40, s62, 0xc00
  s_add_u32 m0, s40, 0
  s_nop 0
  buffer_load_dwordx4 v224, s[4:7], s39 offen lds
  buffer_load_dwordx4 v225, s[4:7], s39 offen offset:1024 lds
  buffer_load_dwordx4 v226, s[4:7], s39 offen offset:2048 lds
  s_add_u32 m0, s40, 0xc000
  s_nop 0
  buffer_load_dwordx4 v224, s[8:11], s39 offen lds
  buffer_load_dwordx4 v225, s[8:11], s39 offen offset:1024 lds
  buffer_load_dwordx4 v226, s[8:11], s39 offen offset:2048 lds
  s_add_u32 s62, s62, 3
  s_cmp_lt_u32 s62, 16
  s_cbranch_scc1 M_dw_loop
M_dw_done:
M_no_dw_early:
  s_lshl_b32 s44, s30, 3
  s_cmp_lg_u32 s28, 0
  s_cbranch_scc1 P_part_done
  s_mov_b32 s51, 0
  v_min_u32 v61, 7, v1
  v_lshlrev_b32 v61, 7, v61
  s_lshl_b32 s50, s44, 7
  s_add_u32 s47, s50, 0x2000000
P_part:
  buffer_load_dword v62, v61, s[20:23], s47 offen sc1
  s_waitcnt vmcnt(0)
  v_cmp_eq_u32 vcc, s90, v62
  s_nop 3
  s_cmp_eq_u64 vcc, exec
  s_cbranch_scc1 P_part_done
  s_add_u32 s51, s51, 1
  s_cmp_lt_u32 s51, 0x40000
  s_sleep 1
  s_cbranch_scc1 P_part
P_part_done:
  s_barrier
  s_add_u32 s39, s68, 0
  buffer_load_dwordx4 v[64:67], v8, s[20:23], s39 offen sc1
  s_add_u32 s39, s68, 0x2000
  buffer_load_dwordx4 v[96:99], v8, s[20:23], s39 offen sc1
  s_add_u32 s39, s68, 0x220000
  buffer_load_dwordx4 v[68:71], v8, s[20:23], s39 offen sc1
  s_add_u32 s39, s68, 0x222000
  buffer_load_dwordx4 v[100:103], v8, s[20:23], s39 offen sc1
  s_add_u32 s39, s68, 0x440000
  buffer_load_dwordx4 v[72:75], v8, s[20:23], s39 offen sc1
  s_add_u32 s39, s68, 0x442000
  buffer_load_dwordx4 v[104:107], v8, s[20:23], s39 offen sc1
  s_add_u32 s39, s68, 0x660000
  buffer_load_dwordx4 v[76:79], v8, s[20:23], s39 offen sc1
  s_add_u32 s39, s68, 0x662000
  buffer_load_dwordx4 v[108:111], v8, s[20:23], s39 offen sc1
  s_add_u32 s39, s68, 0x880000
  buffer_load_dwordx4 v[80:83], v8, s[20:23], s39 offen sc1
  s_add_u32 s39, s68, 0x882000
  buffer_load_dwordx4 v[112:115], v8, s[20:23], s39 offen sc1
  s_add_u32 s39, s68, 0xaa0000
  buffer_load_dwordx4 v[84:87], v8, s[20:23], s39 offen sc1
  s_add_u32 s39, s68, 0xaa2000
  buffer_load_dwordx4 v[116:119], v8, s[20:23], s39 offen sc1
  s_add_u32 s39, s68, 0xcc0000
  buffer_load_dwordx4 v[88:91], v8, s[20:23], s39 offen sc1
  s_add_u32 s39, s68, 0xcc2000
  buffer_load_dwordx4 v[120:123], v8, s[20:23], s39 offen sc1
  s_add_u32 s39, s68, 0xee0000
  buffer_load_dwordx4 v[92:95], v8, s[20:23], s39 offen sc1
  s_add_u32 s39, s68, 0xee2000
  buffer_load_dwordx4 v[124:127], v8, s[20:23], s39 offen sc1
  s_waitcnt vmcnt(15)
  v_mfma_f32_16x16x32_bf16 v[128:131], v[210:213], v[64:67], 0
  v_mfma_f32_16x16x32_bf16 v[132:135], v[208:211], v[64:67], 0
  s_waitcnt vmcnt(14)
  v_mfma_f32_16x16x32_bf16 v[136:139], v[210:213], v[96:99], 0
  v_mfma_f32_16x16x32_bf16 v[140:143], v[208:211], v[96:99], 0
  s_waitcnt vmcnt(13)
  v_mfma_f32_16x16x32_bf16 v[128:131], v[210:213], v[68:71], v[128:131]
  v_mfma_f32_16x16x32_bf16 v[132:135], v[208:211], v[68:71], v[132:135]
  s_waitcnt vmcnt(12)
  v_mfma_f32_16x16x32_bf16 v[136:139], v[210:213], v[100:103], v[136:139]
  v_mfma_f32_16x16x32_bf16 v[140:143], v[208:211], v[100:103], v[140:143]
  s_waitcnt vmcnt(11)
  v_mfma_f32_16x16x32_bf16 v[128:131], v[210:213], v[72:75], v[128:131]
  v_mfma_f32_16x16x32_bf16 v[132:135], v[208:211], v[72:75], v[132:135]
  s_waitcnt vmcnt(10)
  v_mfma_f32_16x16x32_bf16 v[136:139], v[210:213], v[104:107], v[136:139]
  v_mfma_f32_16x16x32_bf16 v[140:143], v[208:211], v[104:107], v[140:143]
  s_waitcnt vmcnt(9)
  v_mfma_f32_16x16x32_bf16 v[128:131], v[210:213], v[76:79], v[128:131]
  v_mfma_f32_16x16x32_bf16 v[132:135], v[208:211], v[76:79], v[132:135]
  s_waitcnt vmcnt(8)
  v_mfma_f32_16x16x32_bf16 v[136:139], v[210:213], v[108:111], v[136:139]
  v_mfma_f32_16x16x32_bf16 v[140:143], v[208:211], v[108:111], v[140:143]
  s_waitcnt vmcnt(7)
  v_mfma_f32_16x16x32_bf16 v[128:131], v[210:213], v[80:83], v[128:131]
  v_mfma_f32_16x16x32_bf16 v[132:135], v[208:211], v[80:83], v[132:135]
  s_waitcnt vmcnt(6)
  v_mfma_f32_16x16x32_bf16 v[136:139], v[210:213], v[112:115], v[136:139]
  v_mfma_f32_16x16x32_bf16 v[140:143], v[208:211], v[112:115], v[140:143]
  s_waitcnt vmcnt(5)
  v_mfma_f32_16x16x32_bf16 v[128:131], v[210:213], v[84:87], v[128:131]
  v_mfma_f32_16x16x32_bf16 v[132:135], v[208:211], v[84:87], v[132:135]
  s_waitcnt vmcnt(4)
  v_mfma_f32_16x16x32_bf16 v[136:139], v[210:213], v[116:119], v[136:139]
  v_mfma_f32_16x16x32_bf16 v[140:143], v[208:211], v[116:119], v[140:143]
  s_waitcnt vmcnt(3)
  v_mfma_f32_16x16x32_bf16 v[128:131], v[210:213], v[88:91], v[128:131]
  v_mfma_f32_16x16x32_bf16 v[132:135], v[208:211], v[88:91], v[132:135]
  s_waitcnt vmcnt(2)
  v_mfma_f32_16x16x32_bf16 v[136:139], v[210:213], v[120:123], v[136:139]
  v_mfma_f32_16x16x32_bf16 v[140:143], v[208:211], v[120:123], v[140:143]
  s_waitcnt vmcnt(1)
  v_mfma_f32_16x16x32_bf16 v[128:131], v[210:213], v[92:95], v[128:131]
  v_mfma_f32_16x16x32_bf16 v[132:135], v[208:211], v[92:95], v[132:135]
  s_waitcnt vmcnt(0)
  v_mfma_f32_16x16x32_bf16 v[136:139], v[210:213], v[124:127], v[136:139]
  v_mfma_f32_16x16x32_bf16 v[140:143], v[208:211], v[124:127], v[140:143]
  v_lshlrev_b32 v144, 16, v12
  v_and_b32 v145, s46, v12
  v_lshlrev_b32 v146, 16, v13
  v_and_b32 v147, s46, v13
  v_lshlrev_b32 v148, 16, v14
  v_and_b32 v149, s46, v14
  v_lshlrev_b32 v150, 16, v15
  v_and_b32 v151, s46, v15
  v_lshlrev_b32 v152, 16, v16
  v_and_b32 v153, s46, v16
  v_lshlrev_b32 v154, 16, v17
  v_and_b32 v155, s46, v17
  v_lshlrev_b32 v156, 16, v18
  v_and_b32 v157, s46, v18
  v_lshlrev_b32 v158, 16, v19
  v_and_b32 v159, s46, v19
  v_fmac_f32 v144, v128, v160
  v_fmac_f32 v145, v129, v161
  v_fmac_f32 v146, v130, v162
  v_fmac_f32 v147, v131, v163
  v_fmac_f32 v148, v132, v164
  v_fmac_f32 v149, v133, v165
  v_fmac_f32 v150, v134, v166
  v_fmac_f32 v151, v135, v167
  v_fmac_f32 v152, v136, v168
  v_fmac_f32 v153, v137, v169
  v_fmac_f32 v154, v138, v170
  v_fmac_f32 v155, v139, v171
  v_fmac_f32 v156, v140, v172
  v_fmac_f32 v157, v141, v173
  v_fmac_f32 v158, v142, v174
  v_fmac_f32 v159, v143, v175
  v_cvt_pk_bf16_f32 v20, v144, v145
  v_cvt_pk_bf16_f32 v21, v146, v147
  v_cvt_pk_bf16_f32 v22, v148, v149
  v_cvt_pk_bf16_f32 v23, v150, v151
  v_cvt_pk_bf16_f32 v24, v152, v153
  v_cvt_pk_bf16_f32 v25, v154, v155
  v_cvt_pk_bf16_f32 v26, v156, v157
  v_cvt_pk_bf16_f32 v27, v158, v159
  s_lshl_b32 s44, s30, 16
  s_lshl_b32 s39, s28, 14
  s_add_u32 s44, s44, s39
  s_lshl_b32 s39, s66, 10
  s_add_u32 s44, s44, s39
  s_add_u32 s39, s44, 0x211000
  buffer_store_dwordx4 v[20:23], v8, s[20:23], s39 offen sc1
  s_add_u32 s39, s44, 0x213000
  buffer_store_dwordx4 v[24:27], v8, s[20:23], s39 offen sc1
  v_lshlrev_b32 v144, 16, v20
  v_and_b32 v145, s46, v20
  v_lshlrev_b32 v146, 16, v21
  v_and_b32 v147, s46, v21
  v_lshlrev_b32 v148, 16, v22
  v_and_b32 v149, s46, v22
  v_lshlrev_b32 v150, 16, v23
  v_and_b32 v151, s46, v23
  v_lshlrev_b32 v152, 16, v24
  v_and_b32 v153, s46, v24
  v_lshlrev_b32 v154, 16, v25
  v_and_b32 v155, s46, v25
  v_lshlrev_b32 v156, 16, v26
  v_and_b32 v157, s46, v26
  v_lshlrev_b32 v158, 16, v27
  v_and_b32 v159, s46, v27
  v_add_f32 v28, v144, v145
  v_mul_f32 v29, v144, v144
  v_fmac_f32 v29, v145, v145
  v_add_f32 v28, v28, v146
  v_fmac_f32 v29, v146, v146
  v_add_f32 v28, v28, v147
  v_fmac_f32 v29, v147, v147
  v_add_f32 v28, v28, v148
  v_fmac_f32 v29, v148, v148
  v_add_f32 v28, v28, v149
  v_fmac_f32 v29, v149, v149
  v_add_f32 v28, v28, v150
  v_fmac_f32 v29, v150, v150
  v_add_f32 v28, v28, v151
  v_fmac_f32 v29, v151, v151
  v_add_f32 v28, v28, v152
  v_fmac_f32 v29, v152, v152
  v_add_f32 v28, v28, v153
  v_fmac_f32 v29, v153, v153
  v_add_f32 v28, v28, v154
  v_fmac_f32 v29, v154, v154
  v_add_f32 v28, v28, v155
  v_fmac_f32 v29, v155, v155
  v_add_f32 v28, v28, v156
  v_fmac_f32 v29, v156, v156
  v_add_f32 v28, v28, v157
  v_fmac_f32 v29, v157, v157
  v_add_f32 v28, v28, v158
  v_fmac_f32 v29, v158, v158
  v_add_f32 v28, v28, v159
  v_fmac_f32 v29, v159, v159
  s_nop 0
  v_add_f32_dpp v28, v28, v28 row_ror:8 row_mask:0xf bank_mask:0xf
  v_add_f32_dpp v29, v29, v29 row_ror:8 row_mask:0xf bank_mask:0xf
  v_mov_b32 v5, v28
  v_mov_b32 v6, v29
  s_nop 0
  v_permlane16_swap_b32 v28, v5
  v_permlane16_swap_b32 v29, v6
  v_add_f32 v28, v28, v5
  v_add_f32 v29, v29, v6
  v_mov_b32 v5, v28
  v_mov_b32 v6, v29
  s_nop 0
  v_permlane32_swap_b32 v28, v5
  v_permlane32_swap_b32 v29, v6
  v_add_f32 v28, v28, v5
  v_add_f32 v29, v29, v6
  v_lshlrev_b32 v5, 3, v3
  v_add_u32 v5, 0x27e00, v5
  s_lshl_b32 s39, s28, 6
  v_add_u32 v6, s39, v5
  v_mov_b32 v30, v28
  v_mov_b32 v31, v29
  ds_write_b64 v6, v[30:31]
  s_waitcnt lgkmcnt(0)
  s_barrier
  ds_read_b64 v[32:33], v5
  ds_read_b64 v[34:35], v5 offset:64
  ds_read_b64 v[36:37], v5 offset:128
  ds_read_b64 v[38:39], v5 offset:192
  s_waitcnt lgkmcnt(2)
  v_add_f32 v28, v32, v34
  v_add_f32 v29, v33, v35
  s_waitcnt lgkmcnt(0)
  v_add_f32 v36, v36, v38
  v_add_f32 v37, v37, v39
  v_add_f32 v28, v28, v36
  v_add_f32 v29, v29, v37
  v_mul_f32 v40, 0x3b000000, v28
  v_mul_f32 v29, 0x3b000000, v29
  v_fma_f32 v29, -v40, v40, v29
  v_max_f32 v29, 0, v29
  v_add_f32 v29, 0x3727c5ac, v29
  v_rsq_f32 v42, v29
  s_nop 0
  v_mul_f32_e64 v44, -v40, v42
  v_mov_b32 v43, v42
  v_mov_b32 v45, v44
  v_pk_fma_f32 v[144:145], v[144:145], v[42:43], v[44:45]
  v_pk_fma_f32 v[146:147], v[146:147], v[42:43], v[44:45]
  v_pk_fma_f32 v[148:149], v[148:149], v[42:43], v[44:45]
  v_pk_fma_f32 v[150:151], v[150:151], v[42:43], v[44:45]
  v_pk_fma_f32 v[152:153], v[152:153], v[42:43], v[44:45]
  v_pk_fma_f32 v[154:155], v[154:155], v[42:43], v[44:45]
  v_pk_fma_f32 v[156:157], v[156:157], v[42:43], v[44:45]
  v_pk_fma_f32 v[158:159], v[158:159], v[42:43], v[44:45]
  v_pk_fma_f32 v[144:145], v[144:145], v[192:193], v[176:177]
  v_pk_fma_f32 v[146:147], v[146:147], v[194:195], v[178:179]
  v_pk_fma_f32 v[148:149], v[148:149], v[196:197], v[180:181]
  v_pk_fma_f32 v[150:151], v[150:151], v[198:199], v[182:183]
  v_pk_fma_f32 v[152:153], v[152:153], v[200:201], v[184:185]
  v_pk_fma_f32 v[154:155], v[154:155], v[202:203], v[186:187]
  v_pk_fma_f32 v[156:157], v[156:157], v[204:205], v[188:189]
  v_pk_fma_f32 v[158:159], v[158:159], v[206:207], v[190:191]
  v_cvt_pk_bf16_f32 v48, v144, v145
  v_cvt_pk_bf16_f32 v49, v146, v147
  v_cvt_pk_bf16_f32 v50, v148, v149
  v_cvt_pk_bf16_f32 v51, v150, v151
  s_add_u32 s39, s44, 0x412000
  buffer_store_dwordx4 v[48:51], v8, s[20:23], s39 offen sc1
  v_cvt_pk_bf16_f32 v52, v152, v153
  v_cvt_pk_bf16_f32 v53, v154, v155
  v_cvt_pk_bf16_f32 v54, v156, v157
  v_cvt_pk_bf16_f32 v55, v158, v159
  s_add_u32 s39, s44, 0x414000
  buffer_store_dwordx4 v[52:55], v8, s[20:23], s39 offen sc1
  s_waitcnt vmcnt(0)
  s_barrier
  s_cmp_lg_u32 s28, 0
  s_cbranch_scc1 S_h2_done
  v_mov_b32 v62, s90
  v_mov_b32 v63, 0
  s_lshl_b32 s50, s2, 7
  s_add_u32 s50, s50, 0x2008000
  s_mov_b64 exec, 1
  buffer_store_dword v62, v63, s[20:23], s50 offen sc1
  s_mov_b64 exec, -1
S_h2_done:
  v_lshlrev_b32 v238, 4, v1
  v_lshlrev_b32 v239, 3, v1
  s_lshl_b32 s39, s29, 2
  s_lshr_b32 s40, s2, 6
  s_add_u32 s56, s39, s40
  s_and_b32 s57, s30, 7
  s_lshl_b32 s60, s28, 14
  s_add_u32 s60, s60, 0x18000
  v_lshrrev_b32 v240, 3, v1
  v_lshlrev_b32 v241, 10, v240
  v_lshrrev_b32 v240, 1, v240
  v_and_b32 v240, 3, v240
  v_lshlrev_b32 v240, 1, v240
  v_and_b32 v242, 7, v1
  v_xor_b32 v240, v240, v242
  v_lshlrev_b32 v240, 4, v240
  v_add_u32 v232, v240, v241
  v_add_u32 v233, 0x1c00, v232
  v_lshrrev_b32 v240, 2, v1
  v_lshlrev_b32 v241, 7, v240
  v_lshrrev_b32 v240, 1, v240
  v_and_b32 v240, 3, v240
  v_lshlrev_b32 v240, 1, v240
  v_and_b32 v242, 3, v1
  v_lshrrev_b32 v243, 1, v242
  v_xor_b32 v240, v240, v243
  v_lshlrev_b32 v240, 4, v240
  v_and_b32 v242, 1, v242
  v_lshlrev_b32 v242, 3, v242
  v_add3_u32 v234, v240, v241, v242
  v_add_u32 v234, s60, v234
  v_xor_b32 v235, 32, v234
  v_xor_b32 v236, 64, v234
  v_xor_b32 v237, 0x60, v234
  s_add_u32 s55, s28, s57
  s_and_b32 s55, s55, 3
  s_lshr_b32 s40, s57, 2
  s_add_u32 s39, s40, 0
  s_cmp_ge_u32 s39, 3
  s_cselect_b32 s70, 3, 0
  s_sub_u32 s39, s39, s70
  s_mul_i32 s70, s39, 0xc000
  s_mul_i32 s73, s39, 0x60000
  s_add_u32 s39, s40, 1
  s_cmp_ge_u32 s39, 3
  s_cselect_b32 s71, 3, 0
  s_sub_u32 s39, s39, s71
  s_mul_i32 s71, s39, 0xc000
  s_mul_i32 s74, s39, 0x60000
  s_add_u32 s39, s40, 2
  s_cmp_ge_u32 s39, 3
  s_cselect_b32 s72, 3, 0
  s_sub_u32 s39, s39, s72
  s_mul_i32 s72, s39, 0xc000
  s_mul_i32 s75, s39, 0x60000
  s_mul_i32 s58, s56, 0x2b800
  s_mul_i32 s39, s55, 0x3000
  s_add_u32 s58, s58, s39
  s_add_u32 s58, s58, 0x613000
  s_mul_i32 s59, s55, 0x18000
  s_lshl_b32 s39, s57, 7
  s_add_u32 s59, s59, s39
  s_cmp_eq_u32 s54, 0
  s_cbranch_scc1 M_no_d
  v_lshlrev_b32 v2, 4, v1
  s_lshl_b32 s41, s52, 2
  s_add_u32 s41, s41, s28
  s_mul_i32 s42, s41, 0x2b800
  s_lshl_b32 s41, s41, 16
  s_add_u32 s41, s41, 0x412000
  s_mul_i32 s39, s53, 0x1800
  s_add_u32 s42, s42, s39
  s_add_u32 s42, s42, 0x613000
  v_lshrrev_b32 v3, 2, v1
  v_mul_u32_u24 v3, 0x60, v3
  v_and_b32 v4, 3, v1
  v_lshlrev_b32 v4, 3, v4
  v_add_u32 v12, v3, v4
  v_add_u32 v13, 0xc000, v12
  v_mov_b32 v196, 0
  v_mov_b32 v197, 0
  v_mov_b32 v198, 0
  v_mov_b32 v199, 0
  s_cmp_eq_u32 s28, 0
  s_cbranch_scc1 M_ee_done_d
  s_sub_u32 s62, s28, 1
M_ee_loop_d:
  s_lshr_b32 s39, s62, 2
  s_and_b32 s40, s62, 3
  s_lshl_b32 s61, s62, 12
  s_add_u32 s61, s61, 0x18000
  s_mul_i32 s63, s40, 48
  s_cmp_eq_u32 s40, 2
  s_cselect_b32 s63, 32, s63
  s_cselect_b32 s69, 48, 16
  s_cmp_eq_u32 s40, 3
  s_cselect_b32 s63, 0, s63
  s_cselect_b32 s47, s74, s73
  s_add_u32 s39, s39, s57
  s_and_b32 s39, s39, 3
  s_mul_i32 s39, s39, 0x60
  s_add_u32 s63, s63, s39
  s_add_u32 s69, s69, s63
  s_lshl_b32 s40, s57, 7
  s_add_u32 s40, s40, s47
  s_lshl_b32 s63, s63, 10
  s_add_u32 s63, s63, s40
  s_add_u32 m0, s61, 0
  s_nop 0
  buffer_load_dwordx4 v232, s[12:15], s63 offen lds
  buffer_load_dwordx4 v233, s[12:15], s63 offen offset:1024 lds
  s_lshl_b32 s69, s69, 10
  s_add_u32 s69, s69, s40
  s_add_u32 m0, s61, 0x800
  s_nop 0
  buffer_load_dwordx4 v232, s[12:15], s69 offen lds
  buffer_load_dwordx4 v233, s[12:15], s69 offen offset:1024 lds
  s_add_u32 s62, s62, 3
  s_cmp_lt_u32 s62, 16
  s_cbranch_scc1 M_ee_loop_d
M_ee_done_d:
  s_lshl_b32 s43, s52, 5
  s_cmp_lg_u32 s28, 0
  s_cbranch_scc1 P_h2_done
  s_mov_b32 s51, 0
  v_min_u32 v61, 31, v1
  v_lshlrev_b32 v61, 7, v61
  s_lshl_b32 s50, s43, 7
  s_add_u32 s47, s50, 0x2008000
P_h2:
  buffer_load_dword v62, v61, s[20:23], s47 offen sc1
  s_waitcnt vmcnt(0)
  v_cmp_eq_u32 vcc, s90, v62
  s_nop 3
  s_cmp_eq_u64 vcc, exec
  s_cbranch_scc1 P_h2_done
  s_add_u32 s51, s51, 1
  s_cmp_lt_u32 s51, 0x40000
  s_sleep 1
  s_cbranch_scc1 P_h2
P_h2_done:
  s_barrier
  s_lshl_b32 s63, s91, 12
  s_add_u32 s40, s41, s63
  buffer_load_dwordx4 v[128:131], v2, s[20:23], s40 offen sc1
  buffer_load_dwordx4 v[132:135], v2, s[20:23], s40 offen offset:1024 sc1
  buffer_load_dwordx4 v[136:139], v2, s[20:23], s40 offen offset:2048 sc1
  buffer_load_dwordx4 v[140:143], v2, s[20:23], s40 offen offset:3072 sc1
  s_add_u32 s63, s63, 0x1000
  s_and_b32 s63, s63, 0xffff
  s_add_u32 s40, s41, s63
  buffer_load_dwordx4 v[144:147], v2, s[20:23], s40 offen sc1
  buffer_load_dwordx4 v[148:151], v2, s[20:23], s40 offen offset:1024 sc1
  buffer_load_dwordx4 v[152:155], v2, s[20:23], s40 offen offset:2048 sc1
  buffer_load_dwordx4 v[156:159], v2, s[20:23], s40 offen offset:3072 sc1
  s_add_u32 s63, s63, 0x1000
  s_and_b32 s63, s63, 0xffff
  s_add_u32 s40, s41, s63
  buffer_load_dwordx4 v[160:163], v2, s[20:23], s40 offen sc1
  buffer_load_dwordx4 v[164:167], v2, s[20:23], s40 offen offset:1024 sc1
  buffer_load_dwordx4 v[168:171], v2, s[20:23], s40 offen offset:2048 sc1
  buffer_load_dwordx4 v[172:175], v2, s[20:23], s40 offen offset:3072 sc1
  v_mfma_f32_32x32x16_bf16 v[16:31], v[196:199], v[196:199], 0
  v_mfma_f32_32x32x16_bf16 v[32:47], v[196:199], v[196:199], 0
  v_mfma_f32_32x32x16_bf16 v[48:63], v[196:199], v[196:199], 0
  v_mfma_f32_32x32x16_bf16 v[64:79], v[196:199], v[196:199], 0
  v_mfma_f32_32x32x16_bf16 v[80:95], v[196:199], v[196:199], 0
  v_mfma_f32_32x32x16_bf16 v[96:111], v[196:199], v[196:199], 0
  ds_read_b64_tr_b16 v[112:113], v12
  ds_read_b64_tr_b16 v[114:115], v12 offset:1536
  ds_read_b64_tr_b16 v[116:117], v12 offset:32
  ds_read_b64_tr_b16 v[118:119], v12 offset:1568
  s_mov_b32 s38, 4
L_gd_4:
  s_waitcnt vmcnt(8) lgkmcnt(2)
  v_mfma_f32_16x16x32_bf16 v[16:19], v[112:115], v[128:131], v[16:19]
  ds_read_b64_tr_b16 v[120:121], v12 offset:64
  s_add_u32 s63, s63, 0x1000
  v_mfma_f32_16x16x32_bf16 v[20:23], v[112:115], v[132:135], v[20:23]
  ds_read_b64_tr_b16 v[122:123], v12 offset:1600
  s_and_b32 s63, s63, 0xffff
  v_mfma_f32_16x16x32_bf16 v[24:27], v[112:115], v[136:139], v[24:27]
  s_add_u32 s40, s41, s63
  v_mfma_f32_16x16x32_bf16 v[28:31], v[112:115], v[140:143], v[28:31]
  s_waitcnt lgkmcnt(2)
  v_mfma_f32_16x16x32_bf16 v[32:35], v[116:119], v[128:131], v[32:35]
  ds_read_b64_tr_b16 v[124:125], v13
  v_mfma_f32_16x16x32_bf16 v[36:39], v[116:119], v[132:135], v[36:39]
  ds_read_b64_tr_b16 v[126:127], v13 offset:1536
  v_mfma_f32_16x16x32_bf16 v[40:43], v[116:119], v[136:139], v[40:43]
  buffer_load_dwordx4 v[176:179], v2, s[20:23], s40 offen sc1
  v_mfma_f32_16x16x32_bf16 v[44:47], v[116:119], v[140:143], v[44:47]
  s_waitcnt lgkmcnt(2)
  v_mfma_f32_16x16x32_bf16 v[48:51], v[120:123], v[128:131], v[48:51]
  ds_read_b64_tr_b16 v[112:113], v13 offset:32
  v_mfma_f32_16x16x32_bf16 v[52:55], v[120:123], v[132:135], v[52:55]
  ds_read_b64_tr_b16 v[114:115], v13 offset:1568
  v_mfma_f32_16x16x32_bf16 v[56:59], v[120:123], v[136:139], v[56:59]
  buffer_load_dwordx4 v[180:183], v2, s[20:23], s40 offen offset:1024 sc1
  v_mfma_f32_16x16x32_bf16 v[60:63], v[120:123], v[140:143], v[60:63]
  s_waitcnt lgkmcnt(2)
  v_mfma_f32_16x16x32_bf16 v[64:67], v[124:127], v[128:131], v[64:67]
  ds_read_b64_tr_b16 v[116:117], v13 offset:64
  v_mfma_f32_16x16x32_bf16 v[68:71], v[124:127], v[132:135], v[68:71]
  ds_read_b64_tr_b16 v[118:119], v13 offset:1600
  v_mfma_f32_16x16x32_bf16 v[72:75], v[124:127], v[136:139], v[72:75]
  buffer_load_dwordx4 v[184:187], v2, s[20:23], s40 offen offset:2048 sc1
  v_mfma_f32_16x16x32_bf16 v[76:79], v[124:127], v[140:143], v[76:79]
  s_waitcnt lgkmcnt(2)
  v_mfma_f32_16x16x32_bf16 v[80:83], v[112:115], v[128:131], v[80:83]
  ds_read_b64_tr_b16 v[120:121], v12 offset:3072
  v_mfma_f32_16x16x32_bf16 v[84:87], v[112:115], v[132:135], v[84:87]
  ds_read_b64_tr_b16 v[122:123], v12 offset:4608
  v_mfma_f32_16x16x32_bf16 v[88:91], v[112:115], v[136:139], v[88:91]
  buffer_load_dwordx4 v[188:191], v2, s[20:23], s40 offen offset:3072 sc1
  v_mfma_f32_16x16x32_bf16 v[92:95], v[112:115], v[140:143], v[92:95]
  s_waitcnt lgkmcnt(2)
  v_mfma_f32_16x16x32_bf16 v[96:99], v[116:119], v[128:131], v[96:99]
  ds_read_b64_tr_b16 v[124:125], v12 offset:3104
  v_mfma_f32_16x16x32_bf16 v[100:103], v[116:119], v[132:135], v[100:103]
  ds_read_b64_tr_b16 v[126:127], v12 offset:4640
  v_mfma_f32_16x16x32_bf16 v[104:107], v[116:119], v[136:139], v[104:107]
  v_mfma_f32_16x16x32_bf16 v[108:111], v[116:119], v[140:143], v[108:111]
  s_waitcnt vmcnt(8) lgkmcnt(2)
  v_mfma_f32_16x16x32_bf16 v[16:19], v[120:123], v[144:147], v[16:19]
  ds_read_b64_tr_b16 v[112:113], v12 offset:3136
  s_add_u32 s63, s63, 0x1000
  v_mfma_f32_16x16x32_bf16 v[20:23], v[120:123], v[148:151], v[20:23]
  ds_read_b64_tr_b16 v[114:115], v12 offset:4672
  s_and_b32 s63, s63, 0xffff
  v_mfma_f32_16x16x32_bf16 v[24:27], v[120:123], v[152:155], v[24:27]
  s_add_u32 s40, s41, s63
  v_mfma_f32_16x16x32_bf16 v[28:31], v[120:123], v[156:159], v[28:31]
  s_waitcnt lgkmcnt(2)
  v_mfma_f32_16x16x32_bf16 v[32:35], v[124:127], v[144:147], v[32:35]
  ds_read_b64_tr_b16 v[116:117], v13 offset:3072
  v_mfma_f32_16x16x32_bf16 v[36:39], v[124:127], v[148:151], v[36:39]
  ds_read_b64_tr_b16 v[118:119], v13 offset:4608
  v_mfma_f32_16x16x32_bf16 v[40:43], v[124:127], v[152:155], v[40:43]
  buffer_load_dwordx4 v[128:131], v2, s[20:23], s40 offen sc1
  v_mfma_f32_16x16x32_bf16 v[44:47], v[124:127], v[156:159], v[44:47]
  s_waitcnt lgkmcnt(2)
  v_mfma_f32_16x16x32_bf16 v[48:51], v[112:115], v[144:147], v[48:51]
  ds_read_b64_tr_b16 v[120:121], v13 offset:3104
  v_mfma_f32_16x16x32_bf16 v[52:55], v[112:115], v[148:151], v[52:55]
  ds_read_b64_tr_b16 v[122:123], v13 offset:4640
  v_mfma_f32_16x16x32_bf16 v[56:59], v[112:115], v[152:155], v[56:59]
  buffer_load_dwordx4 v[132:135], v2, s[20:23], s40 offen offset:1024 sc1
  v_mfma_f32_16x16x32_bf16 v[60:63], v[112:115], v[156:159], v[60:63]
  s_waitcnt lgkmcnt(2)
  v_mfma_f32_16x16x32_bf16 v[64:67], v[116:119], v[144:147], v[64:67]
  ds_read_b64_tr_b16 v[124:125], v13 offset:3136
  v_mfma_f32_16x16x32_bf16 v[68:71], v[116:119], v[148:151], v[68:71]
  ds_read_b64_tr_b16 v[126:127], v13 offset:4672
  v_mfma_f32_16x16x32_bf16 v[72:75], v[116:119], v[152:155], v[72:75]
  buffer_load_dwordx4 v[136:139], v2, s[20:23], s40 offen offset:2048 sc1
  v_mfma_f32_16x16x32_bf16 v[76:79], v[116:119], v[156:159], v[76:79]
  s_waitcnt lgkmcnt(2)
  v_mfma_f32_16x16x32_bf16 v[80:83], v[120:123], v[144:147], v[80:83]
  ds_read_b64_tr_b16 v[112:113], v12 offset:6144
  v_mfma_f32_16x16x32_bf16 v[84:87], v[120:123], v[148:151], v[84:87]
  ds_read_b64_tr_b16 v[114:115], v12 offset:7680
  v_mfma_f32_16x16x32_bf16 v[88:91], v[120:123], v[152:155], v[88:91]
  buffer_load_dwordx4 v[140:143], v2, s[20:23], s40 offen offset:3072 sc1
  v_mfma_f32_16x16x32_bf16 v[92:95], v[120:123], v[156:159], v[92:95]
  s_waitcnt lgkmcnt(2)
  v_mfma_f32_16x16x32_bf16 v[96:99], v[124:127], v[144:147], v[96:99]
  ds_read_b64_tr_b16 v[116:117], v12 offset:6176
  v_mfma_f32_16x16x32_bf16 v[100:103], v[124:127], v[148:151], v[100:103]
  ds_read_b64_tr_b16 v[118:119], v12 offset:7712
  v_mfma_f32_16x16x32_bf16 v[104:107], v[124:127], v[152:155], v[104:107]
  v_mfma_f32_16x16x32_bf16 v[108:111], v[124:127], v[156:159], v[108:111]
  s_waitcnt vmcnt(8) lgkmcnt(2)
  v_mfma_f32_16x16x32_bf16 v[16:19], v[112:115], v[160:163], v[16:19]
  ds_read_b64_tr_b16 v[120:121], v12 offset:6208
  s_add_u32 s63, s63, 0x1000
  v_mfma_f32_16x16x32_bf16 v[20:23], v[112:115], v[164:167], v[20:23]
  ds_read_b64_tr_b16 v[122:123], v12 offset:7744
  s_and_b32 s63, s63, 0xffff
  v_mfma_f32_16x16x32_bf16 v[24:27], v[112:115], v[168:171], v[24:27]
  s_add_u32 s40, s41, s63
  v_mfma_f32_16x16x32_bf16 v[28:31], v[112:115], v[172:175], v[28:31]
  s_waitcnt lgkmcnt(2)
  v_mfma_f32_16x16x32_bf16 v[32:35], v[116:119], v[160:163], v[32:35]
  ds_read_b64_tr_b16 v[124:125], v13 offset:6144
  v_mfma_f32_16x16x32_bf16 v[36:39], v[116:119], v[164:167], v[36:39]
  ds_read_b64_tr_b16 v[126:127], v13 offset:7680
  v_mfma_f32_16x16x32_bf16 v[40:43], v[116:119], v[168:171], v[40:43]
  buffer_load_dwordx4 v[144:147], v2, s[20:23], s40 offen sc1
  v_mfma_f32_16x16x32_bf16 v[44:47], v[116:119], v[172:175], v[44:47]
  s_waitcnt lgkmcnt(2)
  v_mfma_f32_16x16x32_bf16 v[48:51], v[120:123], v[160:163], v[48:51]
  ds_read_b64_tr_b16 v[112:113], v13 offset:6176
  v_mfma_f32_16x16x32_bf16 v[52:55], v[120:123], v[164:167], v[52:55]
  ds_read_b64_tr_b16 v[114:115], v13 offset:7712
  v_mfma_f32_16x16x32_bf16 v[56:59], v[120:123], v[168:171], v[56:59]
  buffer_load_dwordx4 v[148:151], v2, s[20:23], s40 offen offset:1024 sc1
  v_mfma_f32_16x16x32_bf16 v[60:63], v[120:123], v[172:175], v[60:63]
  s_waitcnt lgkmcnt(2)
  v_mfma_f32_16x16x32_bf16 v[64:67], v[124:127], v[160:163], v[64:67]
  ds_read_b64_tr_b16 v[116:117], v13 offset:6208
  v_mfma_f32_16x16x32_bf16 v[68:71], v[124:127], v[164:167], v[68:71]
  ds_read_b64_tr_b16 v[118:119], v13 offset:7744
  v_mfma_f32_16x16x32_bf16 v[72:75], v[124:127], v[168:171], v[72:75]
  buffer_load_dwordx4 v[152:155], v2, s[20:23], s40 offen offset:2048 sc1
  v_mfma_f32_16x16x32_bf16 v[76:79], v[124:127], v[172:175], v[76:79]
  s_waitcnt lgkmcnt(2)
  v_mfma_f32_16x16x32_bf16 v[80:83], v[112:115], v[160:163], v[80:83]
  ds_read_b64_tr_b16 v[120:121], v12 offset:9216
  v_mfma_f32_16x16x32_bf16 v[84:87], v[112:115], v[164:167], v[84:87]
  ds_read_b64_tr_b16 v[122:123], v12 offset:10752
  v_mfma_f32_16x16x32_bf16 v[88:91], v[112:115], v[168:171], v[88:91]
  buffer_load_dwordx4 v[156:159], v2, s[20:23], s40 offen offset:3072 sc1
  v_mfma_f32_16x16x32_bf16 v[92:95], v[112:115], v[172:175], v[92:95]
  s_waitcnt lgkmcnt(2)
  v_mfma_f32_16x16x32_bf16 v[96:99], v[116:119], v[160:163], v[96:99]
  ds_read_b64_tr_b16 v[124:125], v12 offset:9248
  v_mfma_f32_16x16x32_bf16 v[100:103], v[116:119], v[164:167], v[100:103]
  ds_read_b64_tr_b16 v[126:127], v12 offset:10784
  v_mfma_f32_16x16x32_bf16 v[104:107], v[116:119], v[168:171], v[104:107]
  v_mfma_f32_16x16x32_bf16 v[108:111], v[116:119], v[172:175], v[108:111]
  s_waitcnt vmcnt(8) lgkmcnt(2)
  v_mfma_f32_16x16x32_bf16 v[16:19], v[120:123], v[176:179], v[16:19]
  ds_read_b64_tr_b16 v[112:113], v12 offset:9280
  s_add_u32 s63, s63, 0x1000
  v_mfma_f32_16x16x32_bf16 v[20:23], v[120:123], v[180:183], v[20:23]
  ds_read_b64_tr_b16 v[114:115], v12 offset:10816
  s_and_b32 s63, s63, 0xffff
  v_mfma_f32_16x16x32_bf16 v[24:27], v[120:123], v[184:187], v[24:27]
  s_add_u32 s40, s41, s63
  v_mfma_f32_16x16x32_bf16 v[28:31], v[120:123], v[188:191], v[28:31]
  s_waitcnt lgkmcnt(2)
  v_mfma_f32_16x16x32_bf16 v[32:35], v[124:127], v[176:179], v[32:35]
  ds_read_b64_tr_b16 v[116:117], v13 offset:9216
  v_mfma_f32_16x16x32_bf16 v[36:39], v[124:127], v[180:183], v[36:39]
  ds_read_b64_tr_b16 v[118:119], v13 offset:10752
  v_mfma_f32_16x16x32_bf16 v[40:43], v[124:127], v[184:187], v[40:43]
  buffer_load_dwordx4 v[160:163], v2, s[20:23], s40 offen sc1
  v_mfma_f32_16x16x32_bf16 v[44:47], v[124:127], v[188:191], v[44:47]
  s_waitcnt lgkmcnt(2)
  v_mfma_f32_16x16x32_bf16 v[48:51], v[112:115], v[176:179], v[48:51]
  ds_read_b64_tr_b16 v[120:121], v13 offset:9248
  v_mfma_f32_16x16x32_bf16 v[52:55], v[112:115], v[180:183], v[52:55]
  ds_read_b64_tr_b16 v[122:123], v13 offset:10784
  v_mfma_f32_16x16x32_bf16 v[56:59], v[112:115], v[184:187], v[56:59]
  buffer_load_dwordx4 v[164:167], v2, s[20:23], s40 offen offset:1024 sc1
  v_mfma_f32_16x16x32_bf16 v[60:63], v[112:115], v[188:191], v[60:63]
  s_waitcnt lgkmcnt(2)
  v_mfma_f32_16x16x32_bf16 v[64:67], v[116:119], v[176:179], v[64:67]
  ds_read_b64_tr_b16 v[124:125], v13 offset:9280
  v_mfma_f32_16x16x32_bf16 v[68:71], v[116:119], v[180:183], v[68:71]
  ds_read_b64_tr_b16 v[126:127], v13 offset:10816
  v_mfma_f32_16x16x32_bf16 v[72:75], v[116:119], v[184:187], v[72:75]
  buffer_load_dwordx4 v[168:171], v2, s[20:23], s40 offen offset:2048 sc1
  v_mfma_f32_16x16x32_bf16 v[76:79], v[116:119], v[188:191], v[76:79]
  s_waitcnt lgkmcnt(2)
  v_mfma_f32_16x16x32_bf16 v[80:83], v[120:123], v[176:179], v[80:83]
  ds_read_b64_tr_b16 v[112:113], v12 offset:12288
  v_mfma_f32_16x16x32_bf16 v[84:87], v[120:123], v[180:183], v[84:87]
  ds_read_b64_tr_b16 v[114:115], v12 offset:13824
  v_mfma_f32_16x16x32_bf16 v[88:91], v[120:123], v[184:187], v[88:91]
  buffer_load_dwordx4 v[172:175], v2, s[20:23], s40 offen offset:3072 sc1
  v_mfma_f32_16x16x32_bf16 v[92:95], v[120:123], v[188:191], v[92:95]
  s_waitcnt lgkmcnt(2)
  v_mfma_f32_16x16x32_bf16 v[96:99], v[124:127], v[176:179], v[96:99]
  ds_read_b64_tr_b16 v[116:117], v12 offset:12320
  v_mfma_f32_16x16x32_bf16 v[100:103], v[124:127], v[180:183], v[100:103]
  ds_read_b64_tr_b16 v[118:119], v12 offset:13856
  v_mfma_f32_16x16x32_bf16 v[104:107], v[124:127], v[184:187], v[104:107]
  v_mfma_f32_16x16x32_bf16 v[108:111], v[124:127], v[188:191], v[108:111]
  v_add_u32 v12, 0x3000, v12
  v_add_u32 v13, 0x3000, v13
  s_sub_u32 s38, s38, 1
  s_cmp_lg_u32 s38, 0
  s_cbranch_scc1 L_gd_4
  v_mul_f32 v16, v16, v64
  v_mul_f32 v17, v17, v65
  v_mul_f32 v18, v18, v66
  v_mul_f32 v19, v19, v67
  v_mul_f32 v32, v32, v80
  v_mul_f32 v33, v33, v81
  v_mul_f32 v34, v34, v82
  v_mul_f32 v35, v35, v83
  v_mul_f32 v48, v48, v96
  v_mul_f32 v49, v49, v97
  v_mul_f32 v50, v50, v98
  v_mul_f32 v51, v51, v99
  v_cvt_pk_bf16_f32 v200, v16, v17
  v_cvt_pk_bf16_f32 v201, v18, v19
  v_cvt_pk_bf16_f32 v202, v32, v33
  v_cvt_pk_bf16_f32 v203, v34, v35
  v_cvt_pk_bf16_f32 v204, v48, v49
  v_cvt_pk_bf16_f32 v205, v50, v51
  buffer_store_dwordx4 v[200:203], v2, s[20:23], s42 offen sc1
  v_mul_f32 v20, v20, v68
  v_mul_f32 v21, v21, v69
  v_mul_f32 v22, v22, v70
  v_mul_f32 v23, v23, v71
  v_mul_f32 v36, v36, v84
  v_mul_f32 v37, v37, v85
  v_mul_f32 v38, v38, v86
  v_mul_f32 v39, v39, v87
  v_mul_f32 v52, v52, v100
  v_mul_f32 v53, v53, v101
  v_mul_f32 v54, v54, v102
  v_mul_f32 v55, v55, v103
  v_cvt_pk_bf16_f32 v208, v20, v21
  v_cvt_pk_bf16_f32 v209, v22, v23
  v_cvt_pk_bf16_f32 v210, v36, v37
  v_cvt_pk_bf16_f32 v211, v38, v39
  v_cvt_pk_bf16_f32 v212, v52, v53
  v_cvt_pk_bf16_f32 v213, v54, v55
  buffer_store_dwordx4 v[208:211], v2, s[20:23], s42 offen offset:1024 sc1
  v_mul_f32 v24, v24, v72
  v_mul_f32 v25, v25, v73
  v_mul_f32 v26, v26, v74
  v_mul_f32 v27, v27, v75
  v_mul_f32 v40, v40, v88
  v_mul_f32 v41, v41, v89
  v_mul_f32 v42, v42, v90
  v_mul_f32 v43, v43, v91
  v_mul_f32 v56, v56, v104
  v_mul_f32 v57, v57, v105
  v_mul_f32 v58, v58, v106
  v_mul_f32 v59, v59, v107
  v_cvt_pk_bf16_f32 v216, v24, v25
  v_cvt_pk_bf16_f32 v217, v26, v27
  v_cvt_pk_bf16_f32 v218, v40, v41
  v_cvt_pk_bf16_f32 v219, v42, v43
  v_cvt_pk_bf16_f32 v220, v56, v57
  v_cvt_pk_bf16_f32 v221, v58, v59
  buffer_store_dwordx4 v[216:219], v2, s[20:23], s42 offen offset:2048 sc1
  v_mul_f32 v28, v28, v76
  v_mul_f32 v29, v29, v77
  v_mul_f32 v30, v30, v78
  v_mul_f32 v31, v31, v79
  v_mul_f32 v44, v44, v92
  v_mul_f32 v45, v45, v93
  v_mul_f32 v46, v46, v94
  v_mul_f32 v47, v47, v95
  v_mul_f32 v60, v60, v108
  v_mul_f32 v61, v61, v109
  v_mul_f32 v62, v62, v110
  v_mul_f32 v63, v63, v111
  v_cvt_pk_bf16_f32 v224, v28, v29
  v_cvt_pk_bf16_f32 v225, v30, v31
  v_cvt_pk_bf16_f32 v226, v44, v45
  v_cvt_pk_bf16_f32 v227, v46, v47
  v_cvt_pk_bf16_f32 v228, v60, v61
  v_cvt_pk_bf16_f32 v229, v62, v63
  buffer_store_dwordx4 v[224:227], v2, s[20:23], s42 offen offset:3072 sc1
  v_lshlrev_b32 v3, 3, v1
  s_add_u32 s39, s42, 0x1000
  s_cmp_eq_u32 s53, 28
  s_cbranch_scc1 D_skip_half
  buffer_store_dwordx2 v[204:205], v3, s[20:23], s39 offen sc1
  buffer_store_dwordx2 v[212:213], v3, s[20:23], s39 offen offset:512 sc1
  buffer_store_dwordx2 v[220:221], v3, s[20:23], s39 offen offset:1024 sc1
  buffer_store_dwordx2 v[228:229], v3, s[20:23], s39 offen offset:1536 sc1
D_skip_half:
  s_lshl_b32 s43, s52, 5
  s_add_u32 s43, s43, s53
  s_waitcnt vmcnt(0)
  s_waitcnt lgkmcnt(0)
  s_barrier
  s_cmp_lg_u32 s28, 0
  s_cbranch_scc1 S_act_done
  v_mov_b32 v62, s90
  v_mov_b32 v63, 0
  s_lshl_b32 s50, s43, 7
  s_add_u32 s50, s50, 0x2010000
  s_mov_b64 exec, 1
  buffer_store_dword v62, v63, s[20:23], s50 offen sc1
  s_mov_b64 exec, -1
S_act_done:
  s_branch M_e
M_no_d:
  s_cmp_eq_u32 s28, 0
  s_cbranch_scc1 M_ee_done_n
  s_sub_u32 s62, s28, 1
M_ee_loop_n:
  s_lshr_b32 s39, s62, 2
  s_and_b32 s40, s62, 3
  s_lshl_b32 s61, s62, 12
  s_add_u32 s61, s61, 0x18000
  s_mul_i32 s63, s40, 48
  s_cmp_eq_u32 s40, 2
  s_cselect_b32 s63, 32, s63
  s_cselect_b32 s69, 48, 16
  s_cmp_eq_u32 s40, 3
  s_cselect_b32 s63, 0, s63
  s_cselect_b32 s47, s74, s73
  s_add_u32 s39, s39, s57
  s_and_b32 s39, s39, 3
  s_mul_i32 s39, s39, 0x60
  s_add_u32 s63, s63, s39
  s_add_u32 s69, s69, s63
  s_lshl_b32 s40, s57, 7
  s_add_u32 s40, s40, s47
  s_lshl_b32 s63, s63, 10
  s_add_u32 s63, s63, s40
  s_add_u32 m0, s61, 0
  s_nop 0
  buffer_load_dwordx4 v232, s[12:15], s63 offen lds
  buffer_load_dwordx4 v233, s[12:15], s63 offen offset:1024 lds
  s_lshl_b32 s69, s69, 10
  s_add_u32 s69, s69, s40
  s_add_u32 m0, s61, 0x800
  s_nop 0
  buffer_load_dwordx4 v232, s[12:15], s69 offen lds
  buffer_load_dwordx4 v233, s[12:15], s69 offen offset:1024 lds
  s_add_u32 s62, s62, 3
  s_cmp_lt_u32 s62, 16
  s_cbranch_scc1 M_ee_loop_n
M_ee_done_n:
  s_waitcnt vmcnt(0)
M_e:
  s_cmp_lg_u32 s2, 0
  s_cbranch_scc1 U_done
  s_cmp_lg_u32 s28, 1
  s_cbranch_scc1 U_done
  v_min_u32 v61, 63, v1
  v_lshlrev_b32 v61, 7, v61
  s_mov_b32 s51, 0
U_poll:
  s_mov_b32 s47, 0x2018000
  buffer_load_dword v56, v61, s[20:23], s47 offen sc1
  s_mov_b32 s47, 0x201a000
  buffer_load_dword v57, v61, s[20:23], s47 offen sc1
  s_mov_b32 s47, 0x201c000
  buffer_load_dword v58, v61, s[20:23], s47 offen sc1
  s_mov_b32 s47, 0x201e000
  buffer_load_dword v59, v61, s[20:23], s47 offen sc1
  s_waitcnt vmcnt(3)
  v_cmp_eq_u32 vcc, s90, v56
  s_nop 3
  s_mov_b64 s[48:49], vcc
  s_waitcnt vmcnt(2)
  v_cmp_eq_u32 vcc, s90, v57
  s_nop 3
  s_and_b64 s[48:49], s[48:49], vcc
  s_waitcnt vmcnt(1)
  v_cmp_eq_u32 vcc, s90, v58
  s_nop 3
  s_and_b64 s[48:49], s[48:49], vcc
  s_waitcnt vmcnt(0)
  v_cmp_eq_u32 vcc, s90, v59
  s_nop 3
  s_and_b64 s[48:49], s[48:49], vcc
  s_cmp_eq_u64 s[48:49], exec
  s_cbranch_scc1 U_go
  s_add_u32 s51, s51, 1
  s_cmp_lt_u32 s51, 0x40000
  s_sleep 1
  s_cbranch_scc1 U_poll
U_go:
  v_mov_b32 v62, s90
  v_mov_b32 v63, 0
  s_mov_b32 s50, 0xf000
  s_mov_b64 exec, 1
  buffer_store_dword v62, v63, s[20:23], s50 offen sc1
  s_mov_b64 exec, -1
U_done:
  s_lshl_b32 s43, s29, 5
  s_cmp_lg_u32 s28, 0
  s_cbranch_scc1 P_act_done
  s_mov_b32 s51, 0
  v_min_u32 v61, 28, v1
  v_lshlrev_b32 v61, 7, v61
  s_lshl_b32 s50, s43, 7
  s_add_u32 s47, s50, 0x2010000
P_act:
  buffer_load_dword v62, v61, s[20:23], s47 offen sc1
  s_waitcnt vmcnt(0)
  v_cmp_eq_u32 vcc, s90, v62
  s_nop 3
  s_cmp_eq_u64 vcc, exec
  s_cbranch_scc1 P_act_done
  s_add_u32 s51, s51, 1
  s_cmp_lt_u32 s51, 0x40000
  s_sleep 1
  s_cbranch_scc1 P_act
P_act_done:
  s_barrier
  s_add_u32 s61, s58, 0
  s_add_u32 s61, s61, s70
  buffer_load_dwordx4 v[96:99], v238, s[20:23], s61 offen sc1
  buffer_load_dwordx4 v[100:103], v238, s[20:23], s61 offen offset:1024 sc1
  buffer_load_dwordx4 v[104:107], v238, s[20:23], s61 offen offset:2048 sc1
  buffer_load_dwordx4 v[108:111], v238, s[20:23], s61 offen offset:3072 sc1
  s_add_u32 s61, s58, 0x1800
  s_add_u32 s61, s61, s70
  buffer_load_dwordx4 v[112:115], v238, s[20:23], s61 offen sc1
  buffer_load_dwordx4 v[116:119], v238, s[20:23], s61 offen offset:1024 sc1
  buffer_load_dwordx4 v[120:123], v238, s[20:23], s61 offen offset:2048 sc1
  buffer_load_dwordx4 v[124:127], v238, s[20:23], s61 offen offset:3072 sc1
  s_add_u32 s61, s58, 0x1000
  s_add_u32 s61, s61, s70
  buffer_load_dwordx2 v[128:129], v239, s[20:23], s61 offen sc1
  buffer_load_dwordx2 v[132:133], v239, s[20:23], s61 offen offset:512 sc1
  buffer_load_dwordx2 v[136:137], v239, s[20:23], s61 offen offset:1024 sc1
  buffer_load_dwordx2 v[140:141], v239, s[20:23], s61 offen offset:1536 sc1
  s_add_u32 s61, s58, 0x2800
  s_add_u32 s61, s61, s70
  buffer_load_dwordx2 v[130:131], v239, s[20:23], s61 offen sc1
  buffer_load_dwordx2 v[134:135], v239, s[20:23], s61 offen offset:512 sc1
  buffer_load_dwordx2 v[138:139], v239, s[20:23], s61 offen offset:1024 sc1
  buffer_load_dwordx2 v[142:143], v239, s[20:23], s61 offen offset:1536 sc1
  s_add_u32 s61, s58, 0
  s_add_u32 s61, s61, s71
  buffer_load_dwordx4 v[144:147], v238, s[20:23], s61 offen sc1
  buffer_load_dwordx4 v[148:151], v238, s[20:23], s61 offen offset:1024 sc1
  buffer_load_dwordx4 v[152:155], v238, s[20:23], s61 offen offset:2048 sc1
  buffer_load_dwordx4 v[156:159], v238, s[20:23], s61 offen offset:3072 sc1
  s_lshl_b32 s39, s56, 16
  s_lshl_b32 s40, s57, 13
  s_add_u32 s39, s39, s40
  s_lshl_b32 s40, s28, 10
  s_add_u32 s39, s39, s40
  s_add_u32 s39, s39, 0x211000
  v_and_b32 v241, 7, v1
  v_lshrrev_b32 v242, 2, v241
  v_lshlrev_b32 v242, 12, v242
  v_and_b32 v243, 1, v241
  v_lshl_add_u32 v242, v243, 9, v242
  v_lshrrev_b32 v243, 3, v1
  v_lshl_add_u32 v242, v243, 4, v242
  v_bfe_u32 v243, v241, 1, 1
  v_lshl_add_u32 v242, v243, 3, v242
  buffer_load_dwordx2 v[160:161], v242, s[20:23], s39 offen sc1
  buffer_load_dwordx2 v[162:163], v242, s[20:23], s39 offen offset:256 sc1
  buffer_load_dwordx2 v[164:165], v242, s[20:23], s39 offen offset:128 sc1
  buffer_load_dwordx2 v[166:167], v242, s[20:23], s39 offen offset:384 sc1
  v_lshlrev_b32 v241, 5, v241
  s_lshl_b32 s39, s57, 8
  s_add_u32 s39, s39, 0x2800
  buffer_load_dwordx4 v[168:171], v241, s[20:23], s39 offen sc1
  buffer_load_dwordx4 v[172:175], v241, s[20:23], s39 offen offset:16 sc1
  ds_read_b64_tr_b16 v[80:81], v234
  ds_read_b64_tr_b16 v[82:83], v234 offset:2048
  ds_read_b64_tr_b16 v[84:85], v235
  ds_read_b64_tr_b16 v[86:87], v235 offset:2048
  s_waitcnt vmcnt(22) lgkmcnt(2)
  v_mfma_f32_16x16x32_bf16 v[16:19], v[80:83], v[96:99], 0
  ds_read_b64_tr_b16 v[88:89], v236
  v_mfma_f32_16x16x32_bf16 v[20:23], v[80:83], v[100:103], 0
  ds_read_b64_tr_b16 v[90:91], v236 offset:2048
  v_mfma_f32_16x16x32_bf16 v[24:27], v[80:83], v[104:107], 0
  v_mfma_f32_16x16x32_bf16 v[28:31], v[80:83], v[108:111], 0
  s_waitcnt lgkmcnt(2)
  v_mfma_f32_16x16x32_bf16 v[32:35], v[84:87], v[96:99], 0
  ds_read_b64_tr_b16 v[92:93], v237
  v_mfma_f32_16x16x32_bf16 v[36:39], v[84:87], v[100:103], 0
  ds_read_b64_tr_b16 v[94:95], v237 offset:2048
  v_mfma_f32_16x16x32_bf16 v[40:43], v[84:87], v[104:107], 0
  v_mfma_f32_16x16x32_bf16 v[44:47], v[84:87], v[108:111], 0
  s_waitcnt lgkmcnt(2)
  v_mfma_f32_16x16x32_bf16 v[48:51], v[88:91], v[96:99], 0
  ds_read_b64_tr_b16 v[80:81], v234 offset:4096
  v_mfma_f32_16x16x32_bf16 v[52:55], v[88:91], v[100:103], 0
  ds_read_b64_tr_b16 v[82:83], v234 offset:6144
  v_mfma_f32_16x16x32_bf16 v[56:59], v[88:91], v[104:107], 0
  v_mfma_f32_16x16x32_bf16 v[60:63], v[88:91], v[108:111], 0
  s_waitcnt lgkmcnt(2)
  v_mfma_f32_16x16x32_bf16 v[64:67], v[92:95], v[96:99], 0
  ds_read_b64_tr_b16 v[84:85], v235 offset:4096
  v_mfma_f32_16x16x32_bf16 v[68:71], v[92:95], v[100:103], 0
  ds_read_b64_tr_b16 v[86:87], v235 offset:6144
  v_mfma_f32_16x16x32_bf16 v[72:75], v[92:95], v[104:107], 0
  v_mfma_f32_16x16x32_bf16 v[76:79], v[92:95], v[108:111], 0
  s_waitcnt vmcnt(18) lgkmcnt(2)
  v_mfma_f32_16x16x32_bf16 v[16:19], v[80:83], v[112:115], v[16:19]
  ds_read_b64_tr_b16 v[88:89], v236 offset:4096
  v_mfma_f32_16x16x32_bf16 v[20:23], v[80:83], v[116:119], v[20:23]
  ds_read_b64_tr_b16 v[90:91], v236 offset:6144
  s_add_u32 s62, s59, 0xc000
  s_add_u32 s62, s62, s74
  s_add_u32 m0, s60, 0
  v_mfma_f32_16x16x32_bf16 v[24:27], v[80:83], v[120:123], v[24:27]
  buffer_load_dwordx4 v232, s[12:15], s62 offen lds
  v_mfma_f32_16x16x32_bf16 v[28:31], v[80:83], v[124:127], v[28:31]
  buffer_load_dwordx4 v233, s[12:15], s62 offen offset:1024 lds
  s_waitcnt lgkmcnt(2)
  v_mfma_f32_16x16x32_bf16 v[32:35], v[84:87], v[112:115], v[32:35]
  ds_read_b64_tr_b16 v[92:93], v237 offset:4096
  v_mfma_f32_16x16x32_bf16 v[36:39], v[84:87], v[116:119], v[36:39]
  ds_read_b64_tr_b16 v[94:95], v237 offset:6144
  s_add_u32 s62, s59, 0x10000
  s_add_u32 s62, s62, s74
  s_add_u32 m0, s60, 0x800
  v_mfma_f32_16x16x32_bf16 v[40:43], v[84:87], v[120:123], v[40:43]
  buffer_load_dwordx4 v232, s[12:15], s62 offen lds
  v_mfma_f32_16x16x32_bf16 v[44:47], v[84:87], v[124:127], v[44:47]
  buffer_load_dwordx4 v233, s[12:15], s62 offen offset:1024 lds
  s_waitcnt lgkmcnt(2)
  v_mfma_f32_16x16x32_bf16 v[48:51], v[88:91], v[112:115], v[48:51]
  ds_read_b64_tr_b16 v[80:81], v234 offset:8192
  v_mfma_f32_16x16x32_bf16 v[52:55], v[88:91], v[116:119], v[52:55]
  ds_read_b64_tr_b16 v[82:83], v234 offset:10240
  s_add_u32 s61, s58, 0x1800
  s_add_u32 s61, s61, s71
  v_mfma_f32_16x16x32_bf16 v[56:59], v[88:91], v[120:123], v[56:59]
  buffer_load_dwordx4 v[96:99], v238, s[20:23], s61 offen sc1
  v_mfma_f32_16x16x32_bf16 v[60:63], v[88:91], v[124:127], v[60:63]
  buffer_load_dwordx4 v[100:103], v238, s[20:23], s61 offen offset:1024 sc1
  s_waitcnt lgkmcnt(2)
  v_mfma_f32_16x16x32_bf16 v[64:67], v[92:95], v[112:115], v[64:67]
  ds_read_b64_tr_b16 v[84:85], v235 offset:8192
  v_mfma_f32_16x16x32_bf16 v[68:71], v[92:95], v[116:119], v[68:71]
  ds_read_b64_tr_b16 v[86:87], v235 offset:10240
  v_mfma_f32_16x16x32_bf16 v[72:75], v[92:95], v[120:123], v[72:75]
  buffer_load_dwordx4 v[104:107], v238, s[20:23], s61 offen offset:2048 sc1
  v_mfma_f32_16x16x32_bf16 v[76:79], v[92:95], v[124:127], v[76:79]
  buffer_load_dwordx4 v[108:111], v238, s[20:23], s61 offen offset:3072 sc1
  s_waitcnt vmcnt(18) lgkmcnt(2)
  v_mfma_f32_16x16x32_bf16 v[16:19], v[80:83], v[128:131], v[16:19]
  ds_read_b64_tr_b16 v[88:89], v236 offset:8192
  v_mfma_f32_16x16x32_bf16 v[20:23], v[80:83], v[132:135], v[20:23]
  ds_read_b64_tr_b16 v[90:91], v236 offset:10240
  s_add_u32 s62, s59, 0x8000
  s_add_u32 s62, s62, s74
  s_add_u32 m0, s60, 0x1000
  v_mfma_f32_16x16x32_bf16 v[24:27], v[80:83], v[136:139], v[24:27]
  buffer_load_dwordx4 v232, s[12:15], s62 offen lds
  v_mfma_f32_16x16x32_bf16 v[28:31], v[80:83], v[140:143], v[28:31]
  buffer_load_dwordx4 v233, s[12:15], s62 offen offset:1024 lds
  s_waitcnt lgkmcnt(2)
  v_mfma_f32_16x16x32_bf16 v[32:35], v[84:87], v[128:131], v[32:35]
  ds_read_b64_tr_b16 v[92:93], v237 offset:8192
  v_mfma_f32_16x16x32_bf16 v[36:39], v[84:87], v[132:135], v[36:39]
  ds_read_b64_tr_b16 v[94:95], v237 offset:10240
  s_add_u32 s62, s59, 0x14000
  s_add_u32 s62, s62, s74
  s_add_u32 m0, s60, 0x1800
  v_mfma_f32_16x16x32_bf16 v[40:43], v[84:87], v[136:139], v[40:43]
  buffer_load_dwordx4 v232, s[12:15], s62 offen lds
  v_mfma_f32_16x16x32_bf16 v[44:47], v[84:87], v[140:143], v[44:47]
  buffer_load_dwordx4 v233, s[12:15], s62 offen offset:1024 lds
  s_waitcnt lgkmcnt(2)
  v_mfma_f32_16x16x32_bf16 v[48:51], v[88:91], v[128:131], v[48:51]
  ds_read_b64_tr_b16 v[80:81], v234 offset:12288
  v_mfma_f32_16x16x32_bf16 v[52:55], v[88:91], v[132:135], v[52:55]
  ds_read_b64_tr_b16 v[82:83], v234 offset:14336
  s_add_u32 s61, s58, 0x1000
  s_add_u32 s61, s61, s71
  v_mfma_f32_16x16x32_bf16 v[56:59], v[88:91], v[136:139], v[56:59]
  buffer_load_dwordx2 v[112:113], v239, s[20:23], s61 offen sc1
  v_mfma_f32_16x16x32_bf16 v[60:63], v[88:91], v[140:143], v[60:63]
  buffer_load_dwordx2 v[116:117], v239, s[20:23], s61 offen offset:512 sc1
  s_waitcnt lgkmcnt(2)
  v_mfma_f32_16x16x32_bf16 v[64:67], v[92:95], v[128:131], v[64:67]
  ds_read_b64_tr_b16 v[84:85], v235 offset:12288
  v_mfma_f32_16x16x32_bf16 v[68:71], v[92:95], v[132:135], v[68:71]
  ds_read_b64_tr_b16 v[86:87], v235 offset:14336
  v_mfma_f32_16x16x32_bf16 v[72:75], v[92:95], v[136:139], v[72:75]
  buffer_load_dwordx2 v[120:121], v239, s[20:23], s61 offen offset:1024 sc1
  v_mfma_f32_16x16x32_bf16 v[76:79], v[92:95], v[140:143], v[76:79]
  buffer_load_dwordx2 v[124:125], v239, s[20:23], s61 offen offset:1536 sc1
  s_add_u32 s61, s58, 0x2800
  s_add_u32 s61, s61, s71
  buffer_load_dwordx2 v[114:115], v239, s[20:23], s61 offen sc1
  buffer_load_dwordx2 v[118:119], v239, s[20:23], s61 offen offset:512 sc1
  buffer_load_dwordx2 v[122:123], v239, s[20:23], s61 offen offset:1024 sc1
  buffer_load_dwordx2 v[126:127], v239, s[20:23], s61 offen offset:1536 sc1
  s_waitcnt vmcnt(26) lgkmcnt(2)
  v_mfma_f32_16x16x32_bf16 v[16:19], v[80:83], v[144:147], v[16:19]
  ds_read_b64_tr_b16 v[88:89], v236 offset:12288
  v_mfma_f32_16x16x32_bf16 v[20:23], v[80:83], v[148:151], v[20:23]
  ds_read_b64_tr_b16 v[90:91], v236 offset:14336
  s_add_u32 s62, s59, 0
  s_add_u32 s62, s62, s75
  s_add_u32 m0, s60, 0x2000
  v_mfma_f32_16x16x32_bf16 v[24:27], v[80:83], v[152:155], v[24:27]
  buffer_load_dwordx4 v232, s[12:15], s62 offen lds
  v_mfma_f32_16x16x32_bf16 v[28:31], v[80:83], v[156:159], v[28:31]
  buffer_load_dwordx4 v233, s[12:15], s62 offen offset:1024 lds
  s_waitcnt lgkmcnt(2)
  v_mfma_f32_16x16x32_bf16 v[32:35], v[84:87], v[144:147], v[32:35]
  ds_read_b64_tr_b16 v[92:93], v237 offset:12288
  v_mfma_f32_16x16x32_bf16 v[36:39], v[84:87], v[148:151], v[36:39]
  ds_read_b64_tr_b16 v[94:95], v237 offset:14336
  s_add_u32 s62, s59, 0x4000
  s_add_u32 s62, s62, s75
  s_add_u32 m0, s60, 0x2800
  v_mfma_f32_16x16x32_bf16 v[40:43], v[84:87], v[152:155], v[40:43]
  buffer_load_dwordx4 v232, s[12:15], s62 offen lds
  v_mfma_f32_16x16x32_bf16 v[44:47], v[84:87], v[156:159], v[44:47]
  buffer_load_dwordx4 v233, s[12:15], s62 offen offset:1024 lds
  s_waitcnt lgkmcnt(2)
  v_mfma_f32_16x16x32_bf16 v[48:51], v[88:91], v[144:147], v[48:51]
  s_waitcnt vmcnt(20)
  ds_read_b64_tr_b16 v[80:81], v234
  v_mfma_f32_16x16x32_bf16 v[52:55], v[88:91], v[148:151], v[52:55]
  ds_read_b64_tr_b16 v[82:83], v234 offset:2048
  s_add_u32 s61, s58, 0
  s_add_u32 s61, s61, s72
  v_mfma_f32_16x16x32_bf16 v[56:59], v[88:91], v[152:155], v[56:59]
  buffer_load_dwordx4 v[128:131], v238, s[20:23], s61 offen sc1
  v_mfma_f32_16x16x32_bf16 v[60:63], v[88:91], v[156:159], v[60:63]
  buffer_load_dwordx4 v[132:135], v238, s[20:23], s61 offen offset:1024 sc1
  s_waitcnt lgkmcnt(2)
  v_mfma_f32_16x16x32_bf16 v[64:67], v[92:95], v[144:147], v[64:67]
  ds_read_b64_tr_b16 v[84:85], v235
  v_mfma_f32_16x16x32_bf16 v[68:71], v[92:95], v[148:151], v[68:71]
  ds_read_b64_tr_b16 v[86:87], v235 offset:2048
  v_mfma_f32_16x16x32_bf16 v[72:75], v[92:95], v[152:155], v[72:75]
  buffer_load_dwordx4 v[136:139], v238, s[20:23], s61 offen offset:2048 sc1
  v_mfma_f32_16x16x32_bf16 v[76:79], v[92:95], v[156:159], v[76:79]
  buffer_load_dwordx4 v[140:143], v238, s[20:23], s61 offen offset:3072 sc1
  s_waitcnt vmcnt(20) lgkmcnt(2)
  v_mfma_f32_16x16x32_bf16 v[16:19], v[80:83], v[96:99], v[16:19]
  ds_read_b64_tr_b16 v[88:89], v236
  v_mfma_f32_16x16x32_bf16 v[20:23], v[80:83], v[100:103], v[20:23]
  ds_read_b64_tr_b16 v[90:91], v236 offset:2048
  s_add_u32 s62, s59, 0xc000
  s_add_u32 s62, s62, s75
  s_add_u32 m0, s60, 0x3000
  v_mfma_f32_16x16x32_bf16 v[24:27], v[80:83], v[104:107], v[24:27]
  buffer_load_dwordx4 v232, s[12:15], s62 offen lds
  v_mfma_f32_16x16x32_bf16 v[28:31], v[80:83], v[108:111], v[28:31]
  buffer_load_dwordx4 v233, s[12:15], s62 offen offset:1024 lds
  s_waitcnt lgkmcnt(2)
  v_mfma_f32_16x16x32_bf16 v[32:35], v[84:87], v[96:99], v[32:35]
  ds_read_b64_tr_b16 v[92:93], v237
  v_mfma_f32_16x16x32_bf16 v[36:39], v[84:87], v[100:103], v[36:39]
  ds_read_b64_tr_b16 v[94:95], v237 offset:2048
  s_add_u32 s62, s59, 0x10000
  s_add_u32 s62, s62, s75
  s_add_u32 m0, s60, 0x3800
  v_mfma_f32_16x16x32_bf16 v[40:43], v[84:87], v[104:107], v[40:43]
  buffer_load_dwordx4 v232, s[12:15], s62 offen lds
  v_mfma_f32_16x16x32_bf16 v[44:47], v[84:87], v[108:111], v[44:47]
  buffer_load_dwordx4 v233, s[12:15], s62 offen offset:1024 lds
  s_waitcnt lgkmcnt(2)
  v_mfma_f32_16x16x32_bf16 v[48:51], v[88:91], v[96:99], v[48:51]
  s_waitcnt vmcnt(20)
  ds_read_b64_tr_b16 v[80:81], v234 offset:4096
  v_mfma_f32_16x16x32_bf16 v[52:55], v[88:91], v[100:103], v[52:55]
  ds_read_b64_tr_b16 v[82:83], v234 offset:6144
  s_add_u32 s61, s58, 0x1800
  s_add_u32 s61, s61, s72
  v_mfma_f32_16x16x32_bf16 v[56:59], v[88:91], v[104:107], v[56:59]
  buffer_load_dwordx4 v[144:147], v238, s[20:23], s61 offen sc1
  v_mfma_f32_16x16x32_bf16 v[60:63], v[88:91], v[108:111], v[60:63]
  buffer_load_dwordx4 v[148:151], v238, s[20:23], s61 offen offset:1024 sc1
  s_waitcnt lgkmcnt(2)
  v_mfma_f32_16x16x32_bf16 v[64:67], v[92:95], v[96:99], v[64:67]
  ds_read_b64_tr_b16 v[84:85], v235 offset:4096
  v_mfma_f32_16x16x32_bf16 v[68:71], v[92:95], v[100:103], v[68:71]
  ds_read_b64_tr_b16 v[86:87], v235 offset:6144
  v_mfma_f32_16x16x32_bf16 v[72:75], v[92:95], v[104:107], v[72:75]
  buffer_load_dwordx4 v[152:155], v238, s[20:23], s61 offen offset:2048 sc1
  v_mfma_f32_16x16x32_bf16 v[76:79], v[92:95], v[108:111], v[76:79]
  buffer_load_dwordx4 v[156:159], v238, s[20:23], s61 offen offset:3072 sc1
  s_waitcnt vmcnt(16) lgkmcnt(2)
  v_mfma_f32_16x16x32_bf16 v[16:19], v[80:83], v[112:115], v[16:19]
  ds_read_b64_tr_b16 v[88:89], v236 offset:4096
  v_mfma_f32_16x16x32_bf16 v[20:23], v[80:83], v[116:119], v[20:23]
  ds_read_b64_tr_b16 v[90:91], v236 offset:6144
  s_add_u32 s62, s59, 0x8000
  s_add_u32 s62, s62, s75
  s_add_u32 m0, s60, 0
  v_mfma_f32_16x16x32_bf16 v[24:27], v[80:83], v[120:123], v[24:27]
  buffer_load_dwordx4 v232, s[12:15], s62 offen lds
  v_mfma_f32_16x16x32_bf16 v[28:31], v[80:83], v[124:127], v[28:31]
  buffer_load_dwordx4 v233, s[12:15], s62 offen offset:1024 lds
  s_waitcnt lgkmcnt(2)
  v_mfma_f32_16x16x32_bf16 v[32:35], v[84:87], v[112:115], v[32:35]
  ds_read_b64_tr_b16 v[92:93], v237 offset:4096
  v_mfma_f32_16x16x32_bf16 v[36:39], v[84:87], v[116:119], v[36:39]
  ds_read_b64_tr_b16 v[94:95], v237 offset:6144
  s_add_u32 s62, s59, 0x14000
  s_add_u32 s62, s62, s75
  s_add_u32 m0, s60, 0x800
  v_mfma_f32_16x16x32_bf16 v[40:43], v[84:87], v[120:123], v[40:43]
  buffer_load_dwordx4 v232, s[12:15], s62 offen lds
  v_mfma_f32_16x16x32_bf16 v[44:47], v[84:87], v[124:127], v[44:47]
  buffer_load_dwordx4 v233, s[12:15], s62 offen offset:1024 lds
  s_waitcnt lgkmcnt(2)
  v_mfma_f32_16x16x32_bf16 v[48:51], v[88:91], v[112:115], v[48:51]
  s_waitcnt vmcnt(16)
  ds_read_b64_tr_b16 v[80:81], v234 offset:8192
  v_mfma_f32_16x16x32_bf16 v[52:55], v[88:91], v[116:119], v[52:55]
  ds_read_b64_tr_b16 v[82:83], v234 offset:10240
  s_add_u32 s61, s58, 0x1000
  s_add_u32 s61, s61, s72
  v_mfma_f32_16x16x32_bf16 v[56:59], v[88:91], v[120:123], v[56:59]
  buffer_load_dwordx2 v[96:97], v239, s[20:23], s61 offen sc1
  v_mfma_f32_16x16x32_bf16 v[60:63], v[88:91], v[124:127], v[60:63]
  buffer_load_dwordx2 v[100:101], v239, s[20:23], s61 offen offset:512 sc1
  s_waitcnt lgkmcnt(2)
  v_mfma_f32_16x16x32_bf16 v[64:67], v[92:95], v[112:115], v[64:67]
  ds_read_b64_tr_b16 v[84:85], v235 offset:8192
  v_mfma_f32_16x16x32_bf16 v[68:71], v[92:95], v[116:119], v[68:71]
  ds_read_b64_tr_b16 v[86:87], v235 offset:10240
  v_mfma_f32_16x16x32_bf16 v[72:75], v[92:95], v[120:123], v[72:75]
  buffer_load_dwordx2 v[104:105], v239, s[20:23], s61 offen offset:1024 sc1
  v_mfma_f32_16x16x32_bf16 v[76:79], v[92:95], v[124:127], v[76:79]
  buffer_load_dwordx2 v[108:109], v239, s[20:23], s61 offen offset:1536 sc1
  s_add_u32 s61, s58, 0x2800
  s_add_u32 s61, s61, s72
  buffer_load_dwordx2 v[98:99], v239, s[20:23], s61 offen sc1
  buffer_load_dwordx2 v[102:103], v239, s[20:23], s61 offen offset:512 sc1
  buffer_load_dwordx2 v[106:107], v239, s[20:23], s61 offen offset:1024 sc1
  buffer_load_dwordx2 v[110:111], v239, s[20:23], s61 offen offset:1536 sc1
  s_waitcnt vmcnt(20) lgkmcnt(2)
  v_mfma_f32_16x16x32_bf16 v[16:19], v[80:83], v[128:131], v[16:19]
  ds_read_b64_tr_b16 v[88:89], v236 offset:8192
  v_mfma_f32_16x16x32_bf16 v[20:23], v[80:83], v[132:135], v[20:23]
  ds_read_b64_tr_b16 v[90:91], v236 offset:10240
  v_mfma_f32_16x16x32_bf16 v[24:27], v[80:83], v[136:139], v[24:27]
  v_mfma_f32_16x16x32_bf16 v[28:31], v[80:83], v[140:143], v[28:31]
  s_waitcnt lgkmcnt(2)
  v_mfma_f32_16x16x32_bf16 v[32:35], v[84:87], v[128:131], v[32:35]
  ds_read_b64_tr_b16 v[92:93], v237 offset:8192
  v_mfma_f32_16x16x32_bf16 v[36:39], v[84:87], v[132:135], v[36:39]
  ds_read_b64_tr_b16 v[94:95], v237 offset:10240
  v_mfma_f32_16x16x32_bf16 v[40:43], v[84:87], v[136:139], v[40:43]
  v_mfma_f32_16x16x32_bf16 v[44:47], v[84:87], v[140:143], v[44:47]
  s_waitcnt lgkmcnt(2)
  v_mfma_f32_16x16x32_bf16 v[48:51], v[88:91], v[128:131], v[48:51]
  s_waitcnt vmcnt(16)
  ds_read_b64_tr_b16 v[80:81], v234 offset:12288
  v_mfma_f32_16x16x32_bf16 v[52:55], v[88:91], v[132:135], v[52:55]
  ds_read_b64_tr_b16 v[82:83], v234 offset:14336
  v_mfma_f32_16x16x32_bf16 v[56:59], v[88:91], v[136:139], v[56:59]
  v_mfma_f32_16x16x32_bf16 v[60:63], v[88:91], v[140:143], v[60:63]
  s_waitcnt lgkmcnt(2)
  v_mfma_f32_16x16x32_bf16 v[64:67], v[92:95], v[128:131], v[64:67]
  ds_read_b64_tr_b16 v[84:85], v235 offset:12288
  v_mfma_f32_16x16x32_bf16 v[68:71], v[92:95], v[132:135], v[68:71]
  ds_read_b64_tr_b16 v[86:87], v235 offset:14336
  v_mfma_f32_16x16x32_bf16 v[72:75], v[92:95], v[136:139], v[72:75]
  v_mfma_f32_16x16x32_bf16 v[76:79], v[92:95], v[140:143], v[76:79]
  s_waitcnt vmcnt(12) lgkmcnt(2)
  v_mfma_f32_16x16x32_bf16 v[16:19], v[80:83], v[144:147], v[16:19]
  ds_read_b64_tr_b16 v[88:89], v236 offset:12288
  v_mfma_f32_16x16x32_bf16 v[20:23], v[80:83], v[148:151], v[20:23]
  ds_read_b64_tr_b16 v[90:91], v236 offset:14336
  v_mfma_f32_16x16x32_bf16 v[24:27], v[80:83], v[152:155], v[24:27]
  v_mfma_f32_16x16x32_bf16 v[28:31], v[80:83], v[156:159], v[28:31]
  s_waitcnt lgkmcnt(2)
  v_mfma_f32_16x16x32_bf16 v[32:35], v[84:87], v[144:147], v[32:35]
  ds_read_b64_tr_b16 v[92:93], v237 offset:12288
  v_mfma_f32_16x16x32_bf16 v[36:39], v[84:87], v[148:151], v[36:39]
  ds_read_b64_tr_b16 v[94:95], v237 offset:14336
  v_mfma_f32_16x16x32_bf16 v[40:43], v[84:87], v[152:155], v[40:43]
  v_mfma_f32_16x16x32_bf16 v[44:47], v[84:87], v[156:159], v[44:47]
  s_waitcnt lgkmcnt(2)
  v_mfma_f32_16x16x32_bf16 v[48:51], v[88:91], v[144:147], v[48:51]
  s_waitcnt vmcnt(8)
  ds_read_b64_tr_b16 v[80:81], v234
  v_mfma_f32_16x16x32_bf16 v[52:55], v[88:91], v[148:151], v[52:55]
  ds_read_b64_tr_b16 v[82:83], v234 offset:2048
  v_mfma_f32_16x16x32_bf16 v[56:59], v[88:91], v[152:155], v[56:59]
  v_mfma_f32_16x16x32_bf16 v[60:63], v[88:91], v[156:159], v[60:63]
  s_waitcnt lgkmcnt(2)
  v_mfma_f32_16x16x32_bf16 v[64:67], v[92:95], v[144:147], v[64:67]
  ds_read_b64_tr_b16 v[84:85], v235
  v_mfma_f32_16x16x32_bf16 v[68:71], v[92:95], v[148:151], v[68:71]
  ds_read_b64_tr_b16 v[86:87], v235 offset:2048
  v_mfma_f32_16x16x32_bf16 v[72:75], v[92:95], v[152:155], v[72:75]
  v_mfma_f32_16x16x32_bf16 v[76:79], v[92:95], v[156:159], v[76:79]
  s_waitcnt vmcnt(0) lgkmcnt(2)
  v_mfma_f32_16x16x32_bf16 v[16:19], v[80:83], v[96:99], v[16:19]
  ds_read_b64_tr_b16 v[88:89], v236
  v_mfma_f32_16x16x32_bf16 v[20:23], v[80:83], v[100:103], v[20:23]
  ds_read_b64_tr_b16 v[90:91], v236 offset:2048
  v_mfma_f32_16x16x32_bf16 v[24:27], v[80:83], v[104:107], v[24:27]
  v_mfma_f32_16x16x32_bf16 v[28:31], v[80:83], v[108:111], v[28:31]
  s_waitcnt lgkmcnt(2)
  v_mfma_f32_16x16x32_bf16 v[32:35], v[84:87], v[96:99], v[32:35]
  ds_read_b64_tr_b16 v[92:93], v237
  v_mfma_f32_16x16x32_bf16 v[36:39], v[84:87], v[100:103], v[36:39]
  ds_read_b64_tr_b16 v[94:95], v237 offset:2048
  v_mfma_f32_16x16x32_bf16 v[40:43], v[84:87], v[104:107], v[40:43]
  v_mfma_f32_16x16x32_bf16 v[44:47], v[84:87], v[108:111], v[44:47]
  s_waitcnt lgkmcnt(2)
  v_mfma_f32_16x16x32_bf16 v[48:51], v[88:91], v[96:99], v[48:51]
  v_mfma_f32_16x16x32_bf16 v[52:55], v[88:91], v[100:103], v[52:55]
  v_mfma_f32_16x16x32_bf16 v[56:59], v[88:91], v[104:107], v[56:59]
  v_mfma_f32_16x16x32_bf16 v[60:63], v[88:91], v[108:111], v[60:63]
  s_waitcnt lgkmcnt(0)
  v_mfma_f32_16x16x32_bf16 v[64:67], v[92:95], v[96:99], v[64:67]
  v_mfma_f32_16x16x32_bf16 v[68:71], v[92:95], v[100:103], v[68:71]
  v_mfma_f32_16x16x32_bf16 v[72:75], v[92:95], v[104:107], v[72:75]
  v_mfma_f32_16x16x32_bf16 v[76:79], v[92:95], v[108:111], v[76:79]
  s_cmp_lt_u32 s55, 2
  s_cbranch_scc1 E_four
  s_cmp_eq_u32 s55, 3
  s_cbranch_scc1 E_red
  s_sub_u32 s58, s58, 0xfffdc000
  s_sub_u32 s59, s59, 0xffee0000
  s_add_u32 s62, s59, 0
  s_add_u32 m0, s60, 0x1000
  s_nop 0
  buffer_load_dwordx4 v232, s[12:15], s62 offen lds
  buffer_load_dwordx4 v233, s[12:15], s62 offen offset:1024 lds
  s_add_u32 s62, s59, 0x4000
  s_add_u32 m0, s60, 0x1800
  s_nop 0
  buffer_load_dwordx4 v232, s[12:15], s62 offen lds
  buffer_load_dwordx4 v233, s[12:15], s62 offen offset:1024 lds
  s_add_u32 s61, s58, 0
  buffer_load_dwordx4 v[112:115], v238, s[20:23], s61 offen sc1
  buffer_load_dwordx4 v[116:119], v238, s[20:23], s61 offen offset:1024 sc1
  buffer_load_dwordx4 v[120:123], v238, s[20:23], s61 offen offset:2048 sc1
  buffer_load_dwordx4 v[124:127], v238, s[20:23], s61 offen offset:3072 sc1
  s_waitcnt vmcnt(4)
  ds_read_b64_tr_b16 v[80:81], v234 offset:4096
  ds_read_b64_tr_b16 v[82:83], v234 offset:6144
  ds_read_b64_tr_b16 v[84:85], v235 offset:4096
  ds_read_b64_tr_b16 v[86:87], v235 offset:6144
  s_waitcnt vmcnt(0) lgkmcnt(2)
  v_mfma_f32_16x16x32_bf16 v[16:19], v[80:83], v[112:115], v[16:19]
  ds_read_b64_tr_b16 v[88:89], v236 offset:4096
  v_mfma_f32_16x16x32_bf16 v[20:23], v[80:83], v[116:119], v[20:23]
  ds_read_b64_tr_b16 v[90:91], v236 offset:6144
  v_mfma_f32_16x16x32_bf16 v[24:27], v[80:83], v[120:123], v[24:27]
  v_mfma_f32_16x16x32_bf16 v[28:31], v[80:83], v[124:127], v[28:31]
  s_waitcnt lgkmcnt(2)
  v_mfma_f32_16x16x32_bf16 v[32:35], v[84:87], v[112:115], v[32:35]
  ds_read_b64_tr_b16 v[92:93], v237 offset:4096
  v_mfma_f32_16x16x32_bf16 v[36:39], v[84:87], v[116:119], v[36:39]
  ds_read_b64_tr_b16 v[94:95], v237 offset:6144
  v_mfma_f32_16x16x32_bf16 v[40:43], v[84:87], v[120:123], v[40:43]
  v_mfma_f32_16x16x32_bf16 v[44:47], v[84:87], v[124:127], v[44:47]
  s_waitcnt lgkmcnt(2)
  v_mfma_f32_16x16x32_bf16 v[48:51], v[88:91], v[112:115], v[48:51]
  v_mfma_f32_16x16x32_bf16 v[52:55], v[88:91], v[116:119], v[52:55]
  v_mfma_f32_16x16x32_bf16 v[56:59], v[88:91], v[120:123], v[56:59]
  v_mfma_f32_16x16x32_bf16 v[60:63], v[88:91], v[124:127], v[60:63]
  s_waitcnt lgkmcnt(0)
  v_mfma_f32_16x16x32_bf16 v[64:67], v[92:95], v[112:115], v[64:67]
  v_mfma_f32_16x16x32_bf16 v[68:71], v[92:95], v[116:119], v[68:71]
  v_mfma_f32_16x16x32_bf16 v[72:75], v[92:95], v[120:123], v[72:75]
  v_mfma_f32_16x16x32_bf16 v[76:79], v[92:95], v[124:127], v[76:79]
  s_branch E_red
E_four:
  s_add_u32 s62, s59, 0x120000
  s_add_u32 m0, s60, 0x1000
  s_nop 0
  buffer_load_dwordx4 v232, s[12:15], s62 offen lds
  buffer_load_dwordx4 v233, s[12:15], s62 offen offset:1024 lds
  s_add_u32 s62, s59, 0x124000
  s_add_u32 m0, s60, 0x1800
  s_nop 0
  buffer_load_dwordx4 v232, s[12:15], s62 offen lds
  buffer_load_dwordx4 v233, s[12:15], s62 offen offset:1024 lds
  s_add_u32 s61, s58, 0x24000
  buffer_load_dwordx4 v[112:115], v238, s[20:23], s61 offen sc1
  buffer_load_dwordx4 v[116:119], v238, s[20:23], s61 offen offset:1024 sc1
  buffer_load_dwordx4 v[120:123], v238, s[20:23], s61 offen offset:2048 sc1
  buffer_load_dwordx4 v[124:127], v238, s[20:23], s61 offen offset:3072 sc1
  s_add_u32 s62, s59, 0x12c000
  s_add_u32 m0, s60, 0x2000
  s_nop 0
  buffer_load_dwordx4 v232, s[12:15], s62 offen lds
  buffer_load_dwordx4 v233, s[12:15], s62 offen offset:1024 lds
  s_add_u32 s62, s59, 0x130000
  s_add_u32 m0, s60, 0x2800
  s_nop 0
  buffer_load_dwordx4 v232, s[12:15], s62 offen lds
  buffer_load_dwordx4 v233, s[12:15], s62 offen offset:1024 lds
  s_add_u32 s61, s58, 0x25800
  buffer_load_dwordx4 v[128:131], v238, s[20:23], s61 offen sc1
  buffer_load_dwordx4 v[132:135], v238, s[20:23], s61 offen offset:1024 sc1
  buffer_load_dwordx4 v[136:139], v238, s[20:23], s61 offen offset:2048 sc1
  buffer_load_dwordx4 v[140:143], v238, s[20:23], s61 offen offset:3072 sc1
  s_add_u32 s62, s59, 0x128000
  s_add_u32 m0, s60, 0x3000
  s_nop 0
  buffer_load_dwordx4 v232, s[12:15], s62 offen lds
  buffer_load_dwordx4 v233, s[12:15], s62 offen offset:1024 lds
  s_add_u32 s62, s59, 0x134000
  s_add_u32 m0, s60, 0x3800
  s_nop 0
  buffer_load_dwordx4 v232, s[12:15], s62 offen lds
  buffer_load_dwordx4 v233, s[12:15], s62 offen offset:1024 lds
  s_add_u32 s61, s58, 0x25000
  buffer_load_dwordx2 v[144:145], v239, s[20:23], s61 offen sc1
  buffer_load_dwordx2 v[148:149], v239, s[20:23], s61 offen offset:512 sc1
  buffer_load_dwordx2 v[152:153], v239, s[20:23], s61 offen offset:1024 sc1
  buffer_load_dwordx2 v[156:157], v239, s[20:23], s61 offen offset:1536 sc1
  s_add_u32 s61, s58, 0x26800
  buffer_load_dwordx2 v[146:147], v239, s[20:23], s61 offen sc1
  buffer_load_dwordx2 v[150:151], v239, s[20:23], s61 offen offset:512 sc1
  buffer_load_dwordx2 v[154:155], v239, s[20:23], s61 offen offset:1024 sc1
  buffer_load_dwordx2 v[158:159], v239, s[20:23], s61 offen offset:1536 sc1
  s_waitcnt vmcnt(24)
  ds_read_b64_tr_b16 v[80:81], v234 offset:4096
  ds_read_b64_tr_b16 v[82:83], v234 offset:6144
  ds_read_b64_tr_b16 v[84:85], v235 offset:4096
  ds_read_b64_tr_b16 v[86:87], v235 offset:6144
  s_waitcnt vmcnt(20) lgkmcnt(2)
  v_mfma_f32_16x16x32_bf16 v[16:19], v[80:83], v[112:115], v[16:19]
  ds_read_b64_tr_b16 v[88:89], v236 offset:4096
  v_mfma_f32_16x16x32_bf16 v[20:23], v[80:83], v[116:119], v[20:23]
  ds_read_b64_tr_b16 v[90:91], v236 offset:6144
  v_mfma_f32_16x16x32_bf16 v[24:27], v[80:83], v[120:123], v[24:27]
  v_mfma_f32_16x16x32_bf16 v[28:31], v[80:83], v[124:127], v[28:31]
  s_waitcnt lgkmcnt(2)
  v_mfma_f32_16x16x32_bf16 v[32:35], v[84:87], v[112:115], v[32:35]
  ds_read_b64_tr_b16 v[92:93], v237 offset:4096
  v_mfma_f32_16x16x32_bf16 v[36:39], v[84:87], v[116:119], v[36:39]
  ds_read_b64_tr_b16 v[94:95], v237 offset:6144
  v_mfma_f32_16x16x32_bf16 v[40:43], v[84:87], v[120:123], v[40:43]
  v_mfma_f32_16x16x32_bf16 v[44:47], v[84:87], v[124:127], v[44:47]
  s_waitcnt lgkmcnt(2)
  v_mfma_f32_16x16x32_bf16 v[48:51], v[88:91], v[112:115], v[48:51]
  s_waitcnt vmcnt(16)
  ds_read_b64_tr_b16 v[80:81], v234 offset:8192
  v_mfma_f32_16x16x32_bf16 v[52:55], v[88:91], v[116:119], v[52:55]
  ds_read_b64_tr_b16 v[82:83], v234 offset:10240
  v_mfma_f32_16x16x32_bf16 v[56:59], v[88:91], v[120:123], v[56:59]
  v_mfma_f32_16x16x32_bf16 v[60:63], v[88:91], v[124:127], v[60:63]
  s_waitcnt lgkmcnt(2)
  v_mfma_f32_16x16x32_bf16 v[64:67], v[92:95], v[112:115], v[64:67]
  ds_read_b64_tr_b16 v[84:85], v235 offset:8192
  v_mfma_f32_16x16x32_bf16 v[68:71], v[92:95], v[116:119], v[68:71]
  ds_read_b64_tr_b16 v[86:87], v235 offset:10240
  v_mfma_f32_16x16x32_bf16 v[72:75], v[92:95], v[120:123], v[72:75]
  v_mfma_f32_16x16x32_bf16 v[76:79], v[92:95], v[124:127], v[76:79]
  s_waitcnt vmcnt(12) lgkmcnt(2)
  v_mfma_f32_16x16x32_bf16 v[16:19], v[80:83], v[128:131], v[16:19]
  ds_read_b64_tr_b16 v[88:89], v236 offset:8192
  v_mfma_f32_16x16x32_bf16 v[20:23], v[80:83], v[132:135], v[20:23]
  ds_read_b64_tr_b16 v[90:91], v236 offset:10240
  v_mfma_f32_16x16x32_bf16 v[24:27], v[80:83], v[136:139], v[24:27]
  v_mfma_f32_16x16x32_bf16 v[28:31], v[80:83], v[140:143], v[28:31]
  s_waitcnt lgkmcnt(2)
  v_mfma_f32_16x16x32_bf16 v[32:35], v[84:87], v[128:131], v[32:35]
  ds_read_b64_tr_b16 v[92:93], v237 offset:8192
  v_mfma_f32_16x16x32_bf16 v[36:39], v[84:87], v[132:135], v[36:39]
  ds_read_b64_tr_b16 v[94:95], v237 offset:10240
  v_mfma_f32_16x16x32_bf16 v[40:43], v[84:87], v[136:139], v[40:43]
  v_mfma_f32_16x16x32_bf16 v[44:47], v[84:87], v[140:143], v[44:47]
  s_waitcnt lgkmcnt(2)
  v_mfma_f32_16x16x32_bf16 v[48:51], v[88:91], v[128:131], v[48:51]
  s_waitcnt vmcnt(8)
  ds_read_b64_tr_b16 v[80:81], v234 offset:12288
  v_mfma_f32_16x16x32_bf16 v[52:55], v[88:91], v[132:135], v[52:55]
  ds_read_b64_tr_b16 v[82:83], v234 offset:14336
  v_mfma_f32_16x16x32_bf16 v[56:59], v[88:91], v[136:139], v[56:59]
  v_mfma_f32_16x16x32_bf16 v[60:63], v[88:91], v[140:143], v[60:63]
  s_waitcnt lgkmcnt(2)
  v_mfma_f32_16x16x32_bf16 v[64:67], v[92:95], v[128:131], v[64:67]
  ds_read_b64_tr_b16 v[84:85], v235 offset:12288
  v_mfma_f32_16x16x32_bf16 v[68:71], v[92:95], v[132:135], v[68:71]
  ds_read_b64_tr_b16 v[86:87], v235 offset:14336
  v_mfma_f32_16x16x32_bf16 v[72:75], v[92:95], v[136:139], v[72:75]
  v_mfma_f32_16x16x32_bf16 v[76:79], v[92:95], v[140:143], v[76:79]
  s_waitcnt vmcnt(0) lgkmcnt(2)
  v_mfma_f32_16x16x32_bf16 v[16:19], v[80:83], v[144:147], v[16:19]
  ds_read_b64_tr_b16 v[88:89], v236 offset:12288
  v_mfma_f32_16x16x32_bf16 v[20:23], v[80:83], v[148:151], v[20:23]
  ds_read_b64_tr_b16 v[90:91], v236 offset:14336
  v_mfma_f32_16x16x32_bf16 v[24:27], v[80:83], v[152:155], v[24:27]
  v_mfma_f32_16x16x32_bf16 v[28:31], v[80:83], v[156:159], v[28:31]
  s_waitcnt lgkmcnt(2)
  v_mfma_f32_16x16x32_bf16 v[32:35], v[84:87], v[144:147], v[32:35]
  ds_read_b64_tr_b16 v[92:93], v237 offset:12288
  v_mfma_f32_16x16x32_bf16 v[36:39], v[84:87], v[148:151], v[36:39]
  ds_read_b64_tr_b16 v[94:95], v237 offset:14336
  v_mfma_f32_16x16x32_bf16 v[40:43], v[84:87], v[152:155], v[40:43]
  v_mfma_f32_16x16x32_bf16 v[44:47], v[84:87], v[156:159], v[44:47]
  s_waitcnt lgkmcnt(2)
  v_mfma_f32_16x16x32_bf16 v[48:51], v[88:91], v[144:147], v[48:51]
  v_mfma_f32_16x16x32_bf16 v[52:55], v[88:91], v[148:151], v[52:55]
  v_mfma_f32_16x16x32_bf16 v[56:59], v[88:91], v[152:155], v[56:59]
  v_mfma_f32_16x16x32_bf16 v[60:63], v[88:91], v[156:159], v[60:63]
  s_waitcnt lgkmcnt(0)
  v_mfma_f32_16x16x32_bf16 v[64:67], v[92:95], v[144:147], v[64:67]
  v_mfma_f32_16x16x32_bf16 v[68:71], v[92:95], v[148:151], v[68:71]
  v_mfma_f32_16x16x32_bf16 v[72:75], v[92:95], v[152:155], v[72:75]
  v_mfma_f32_16x16x32_bf16 v[76:79], v[92:95], v[156:159], v[76:79]
E_red:
  s_waitcnt vmcnt(0) lgkmcnt(0)
  s_lshl_b32 s39, s28, 12
  v_lshrrev_b32 v241, 4, v1
  v_lshrrev_b32 v242, 1, v241
  v_lshl_add_u32 v242, v242, 2, v1
  v_add_u32 v243, 0, v242
  v_and_b32 v243, 15, v243
  v_lshlrev_b32 v243, 4, v243
  v_lshl_add_u32 v243, v241, 8, v243
  v_add_u32 v248, s39, v243
  v_add_u32 v243, 8, v242
  v_and_b32 v243, 15, v243
  v_lshlrev_b32 v243, 4, v243
  v_lshl_add_u32 v243, v241, 8, v243
  v_add_u32 v249, s39, v243
  ds_write_b128 v248, v[16:19]
  ds_write_b128 v249, v[32:35] offset:1024
  ds_write_b128 v248, v[48:51] offset:2048
  ds_write_b128 v249, v[64:67] offset:3072
  ds_write_b128 v248, v[20:23] offset:16384
  ds_write_b128 v249, v[36:39] offset:17408
  ds_write_b128 v248, v[52:55] offset:18432
  ds_write_b128 v249, v[68:71] offset:19456
  ds_write_b128 v248, v[24:27] offset:32768
  ds_write_b128 v249, v[40:43] offset:33792
  ds_write_b128 v248, v[56:59] offset:34816
  ds_write_b128 v249, v[72:75] offset:35840
  ds_write_b128 v248, v[28:31] offset:49152
  ds_write_b128 v249, v[44:47] offset:50176
  ds_write_b128 v248, v[60:63] offset:51200
  s_waitcnt lgkmcnt(14)
  ds_write_b128 v249, v[76:79] offset:52224
  s_waitcnt lgkmcnt(0)
  s_barrier
  s_lshl_b32 s39, s28, 14
  v_and_b32 v241, 7, v1
  v_lshrrev_b32 v242, 1, v241
  v_lshlrev_b32 v240, 10, v242
  v_and_b32 v243, 1, v241
  v_lshl_add_u32 v240, v243, 9, v240
  v_add_u32 v240, s39, v240
  v_and_b32 v242, 1, v242
  v_lshl_add_u32 v242, v242, 1, v243
  v_lshrrev_b32 v243, 3, v1
  v_lshl_add_u32 v242, v242, 2, v243
  v_add_u32 v243, 0, v242
  v_and_b32 v243, 15, v243
  v_lshl_add_u32 v248, v243, 4, v240
  v_add_u32 v243, 8, v242
  v_and_b32 v243, 15, v243
  v_lshl_add_u32 v249, v243, 4, v240
  ds_read_b128 v[96:99], v248
  ds_read_b128 v[100:103], v248 offset:256
  ds_read_b128 v[104:107], v249
  ds_read_b128 v[108:111], v249 offset:256
  ds_read_b128 v[112:115], v248 offset:4096
  ds_read_b128 v[116:119], v248 offset:4352
  ds_read_b128 v[120:123], v249 offset:4096
  ds_read_b128 v[124:127], v249 offset:4352
  ds_read_b128 v[128:131], v248 offset:8192
  ds_read_b128 v[132:135], v248 offset:8448
  ds_read_b128 v[136:139], v249 offset:8192
  ds_read_b128 v[140:143], v249 offset:8448
  ds_read_b128 v[144:147], v248 offset:12288
  ds_read_b128 v[148:151], v248 offset:12544
  ds_read_b128 v[152:155], v249 offset:12288
  s_waitcnt lgkmcnt(14)
  ds_read_b128 v[156:159], v249 offset:12544
  s_waitcnt lgkmcnt(11)
  v_pk_add_f32 v[96:97], v[96:97], v[112:113]
  s_waitcnt lgkmcnt(3)
  v_pk_add_f32 v[128:129], v[128:129], v[144:145]
  v_pk_add_f32 v[98:99], v[98:99], v[114:115]
  v_pk_add_f32 v[130:131], v[130:131], v[146:147]
  v_pk_add_f32 v[100:101], v[100:101], v[116:117]
  s_waitcnt lgkmcnt(2)
  v_pk_add_f32 v[132:133], v[132:133], v[148:149]
  v_pk_add_f32 v[102:103], v[102:103], v[118:119]
  v_pk_add_f32 v[134:135], v[134:135], v[150:151]
  v_pk_add_f32 v[104:105], v[104:105], v[120:121]
  s_waitcnt lgkmcnt(1)
  v_pk_add_f32 v[136:137], v[136:137], v[152:153]
  v_pk_add_f32 v[106:107], v[106:107], v[122:123]
  v_pk_add_f32 v[138:139], v[138:139], v[154:155]
  v_pk_add_f32 v[108:109], v[108:109], v[124:125]
  s_waitcnt lgkmcnt(0)
  v_pk_add_f32 v[140:141], v[140:141], v[156:157]
  v_pk_add_f32 v[110:111], v[110:111], v[126:127]
  v_pk_add_f32 v[142:143], v[142:143], v[158:159]
  v_pk_add_f32 v[96:97], v[96:97], v[128:129]
  v_pk_add_f32 v[98:99], v[98:99], v[130:131]
  v_pk_add_f32 v[100:101], v[100:101], v[132:133]
  v_pk_add_f32 v[102:103], v[102:103], v[134:135]
  v_pk_add_f32 v[104:105], v[104:105], v[136:137]
  v_pk_add_f32 v[106:107], v[106:107], v[138:139]
  v_pk_add_f32 v[108:109], v[108:109], v[140:141]
  v_pk_add_f32 v[110:111], v[110:111], v[142:143]
  v_lshlrev_b32 v184, 16, v160
  v_and_b32 v185, s46, v160
  v_lshlrev_b32 v186, 16, v161
  v_and_b32 v187, s46, v161
  v_lshlrev_b32 v188, 16, v162
  v_and_b32 v189, s46, v162
  v_lshlrev_b32 v190, 16, v163
  v_and_b32 v191, s46, v163
  v_lshlrev_b32 v192, 16, v164
  v_and_b32 v193, s46, v164
  v_lshlrev_b32 v194, 16, v165
  v_and_b32 v195, s46, v165
  v_lshlrev_b32 v196, 16, v166
  v_and_b32 v197, s46, v166
  v_lshlrev_b32 v198, 16, v167
  v_and_b32 v199, s46, v167
  v_fmac_f32 v184, v96, v168
  v_fmac_f32 v185, v97, v169
  v_fmac_f32 v186, v98, v170
  v_fmac_f32 v187, v99, v171
  v_fmac_f32 v188, v100, v172
  v_fmac_f32 v189, v101, v173
  v_fmac_f32 v190, v102, v174
  v_fmac_f32 v191, v103, v175
  v_fmac_f32 v192, v104, v168
  v_fmac_f32 v193, v105, v169
  v_fmac_f32 v194, v106, v170
  v_fmac_f32 v195, v107, v171
  v_fmac_f32 v196, v108, v172
  v_fmac_f32 v197, v109, v173
  v_fmac_f32 v198, v110, v174
  v_fmac_f32 v199, v111, v175
  v_cvt_pk_bf16_f32 v200, v184, v185
  v_cvt_pk_bf16_f32 v201, v186, v187
  v_cvt_pk_bf16_f32 v202, v188, v189
  v_cvt_pk_bf16_f32 v203, v190, v191
  v_cvt_pk_bf16_f32 v204, v192, v193
  v_cvt_pk_bf16_f32 v205, v194, v195
  v_cvt_pk_bf16_f32 v206, v196, v197
  v_cvt_pk_bf16_f32 v207, v198, v199
  v_lshrrev_b32 v240, 3, v1
  v_lshlrev_b32 v240, 10, v240
  v_and_b32 v241, 7, v1
  v_lshl_add_u32 v240, v241, 4, v240
  s_lshl_b32 s39, s56, 6
  s_lshl_b32 s40, s28, 4
  s_add_u32 s39, s39, s40
  s_lshl_b32 s39, s39, 10
  s_lshl_b32 s40, s57, 7
  s_add_u32 s39, s39, s40
  buffer_store_dwordx4 v[200:203], v240, s[16:19], s39 offen sc1
  s_add_u32 s39, s39, 0x2000
  buffer_store_dwordx4 v[204:207], v240, s[16:19], s39 offen sc1
  s_branch B_end
B_slow:
  s_waitcnt vmcnt(0) lgkmcnt(0)
  v_mov_b32 v224, 0xff800000
  v_mov_b32 v225, 0xff800000
  v_mov_b32 v226, 0xff800000
  v_mov_b32 v227, 0xff800000
  v_mov_b32 v228, 0
  v_mov_b32 v229, 0
  v_mov_b32 v230, 0
  v_mov_b32 v231, 0
  s_mov_b32 s43, 0
B_slow_p1:
  s_lshl_b32 s36, s43, 13
  s_mov_b32 s37, s36
  s_add_u32 m0, s33, 0x4000
  s_nop 0
  buffer_load_dwordx4 v10, s[8:11], s36 offen lds
  buffer_load_dwordx4 v11, s[8:11], s36 offen offset:1024 lds
  buffer_load_dwordx4 v12, s[8:11], s36 offen offset:2048 lds
  buffer_load_dwordx4 v13, s[8:11], s36 offen offset:3072 lds
  s_add_u32 m0, s33, 0x5000
  s_nop 0
  buffer_load_dwordx4 v14, s[8:11], s36 offen lds
  buffer_load_dwordx4 v15, s[8:11], s36 offen offset:1024 lds
  buffer_load_dwordx4 v16, s[8:11], s36 offen offset:2048 lds
  buffer_load_dwordx4 v17, s[8:11], s36 offen offset:3072 lds
  s_add_u32 s36, s36, 0x2000
  s_and_b32 s36, s36, 0x1ffff
  s_waitcnt vmcnt(0)
  ds_read_b128 a[164:167], v30 offset:16384
  s_waitcnt lgkmcnt(0)
  v_mfma_f32_16x16x32_bf16 v[128:131], a[164:167], v[64:67], 0
  v_mfma_f32_16x16x32_bf16 v[132:135], a[164:167], v[80:83], 0
  v_mfma_f32_16x16x32_bf16 v[136:139], a[164:167], v[96:99], 0
  v_mfma_f32_16x16x32_bf16 v[140:143], a[164:167], v[112:115], 0
  ds_read_b128 a[168:171], v31 offset:16384
  s_waitcnt lgkmcnt(0)
  v_mfma_f32_16x16x32_bf16 v[128:131], a[168:171], v[68:71], v[128:131]
  v_mfma_f32_16x16x32_bf16 v[132:135], a[168:171], v[84:87], v[132:135]
  v_mfma_f32_16x16x32_bf16 v[136:139], a[168:171], v[100:103], v[136:139]
  v_mfma_f32_16x16x32_bf16 v[140:143], a[168:171], v[116:119], v[140:143]
  ds_read_b128 a[172:175], v32 offset:16384
  s_waitcnt lgkmcnt(0)
  v_mfma_f32_16x16x32_bf16 v[128:131], a[172:175], v[72:75], v[128:131]
  v_mfma_f32_16x16x32_bf16 v[132:135], a[172:175], v[88:91], v[132:135]
  v_mfma_f32_16x16x32_bf16 v[136:139], a[172:175], v[104:107], v[136:139]
  v_mfma_f32_16x16x32_bf16 v[140:143], a[172:175], v[120:123], v[140:143]
  ds_read_b128 a[176:179], v33 offset:16384
  s_waitcnt lgkmcnt(0)
  v_mfma_f32_16x16x32_bf16 v[128:131], a[176:179], v[76:79], v[128:131]
  v_mfma_f32_16x16x32_bf16 v[132:135], a[176:179], v[92:95], v[132:135]
  v_mfma_f32_16x16x32_bf16 v[136:139], a[176:179], v[108:111], v[136:139]
  v_mfma_f32_16x16x32_bf16 v[140:143], a[176:179], v[124:127], v[140:143]
  ds_read_b128 a[164:167], v30 offset:20480
  s_waitcnt lgkmcnt(0)
  v_mfma_f32_16x16x32_bf16 v[144:147], a[164:167], v[64:67], 0
  v_mfma_f32_16x16x32_bf16 v[148:151], a[164:167], v[80:83], 0
  v_mfma_f32_16x16x32_bf16 v[152:155], a[164:167], v[96:99], 0
  v_mfma_f32_16x16x32_bf16 v[156:159], a[164:167], v[112:115], 0
  ds_read_b128 a[168:171], v31 offset:20480
  s_waitcnt lgkmcnt(0)
  v_mfma_f32_16x16x32_bf16 v[144:147], a[168:171], v[68:71], v[144:147]
  v_mfma_f32_16x16x32_bf16 v[148:151], a[168:171], v[84:87], v[148:151]
  v_mfma_f32_16x16x32_bf16 v[152:155], a[168:171], v[100:103], v[152:155]
  v_mfma_f32_16x16x32_bf16 v[156:159], a[168:171], v[116:119], v[156:159]
  ds_read_b128 a[172:175], v32 offset:20480
  s_waitcnt lgkmcnt(0)
  v_mfma_f32_16x16x32_bf16 v[144:147], a[172:175], v[72:75], v[144:147]
  v_mfma_f32_16x16x32_bf16 v[148:151], a[172:175], v[88:91], v[148:151]
  v_mfma_f32_16x16x32_bf16 v[152:155], a[172:175], v[104:107], v[152:155]
  v_mfma_f32_16x16x32_bf16 v[156:159], a[172:175], v[120:123], v[156:159]
  ds_read_b128 a[176:179], v33 offset:20480
  s_waitcnt lgkmcnt(0)
  v_mfma_f32_16x16x32_bf16 v[144:147], a[176:179], v[76:79], v[144:147]
  v_mfma_f32_16x16x32_bf16 v[148:151], a[176:179], v[92:95], v[148:151]
  v_mfma_f32_16x16x32_bf16 v[152:155], a[176:179], v[108:111], v[152:155]
  v_mfma_f32_16x16x32_bf16 v[156:159], a[176:179], v[124:127], v[156:159]
  v_max3_f32 v224, v224, v128, v129
  v_max3_f32 v224, v224, v130, v131
  s_nop 2
  v_max3_f32 v224, v224, v144, v145
  v_max3_f32 v224, v224, v146, v147
  v_max3_f32 v225, v225, v132, v133
  v_max3_f32 v225, v225, v134, v135
  v_max3_f32 v225, v225, v148, v149
  v_max3_f32 v225, v225, v150, v151
  v_max3_f32 v226, v226, v136, v137
  v_max3_f32 v226, v226, v138, v139
  v_max3_f32 v226, v226, v152, v153
  v_max3_f32 v226, v226, v154, v155
  v_max3_f32 v227, v227, v140, v141
  v_max3_f32 v227, v227, v142, v143
  v_max3_f32 v227, v227, v156, v157
  v_max3_f32 v227, v227, v158, v159
  s_waitcnt vmcnt(0) lgkmcnt(0)
  s_add_u32 s43, s43, 1
  s_cmp_lt_u32 s43, 16
  s_cbranch_scc1 B_slow_p1
  v_mov_b32 v232, v224
  s_nop 1
  v_permlane32_swap_b32 v224, v232
  v_max_f32 v224, v224, v232
  v_mov_b32 v232, v224
  s_nop 1
  v_permlane16_swap_b32 v224, v232
  v_max_f32 v224, v224, v232
  v_sub_f32 v208, 0, v224
  v_sub_f32 v209, 0, v224
  v_sub_f32 v210, 0, v224
  v_sub_f32 v211, 0, v224
  v_mov_b32 v232, v225
  s_nop 1
  v_permlane32_swap_b32 v225, v232
  v_max_f32 v225, v225, v232
  v_mov_b32 v232, v225
  s_nop 1
  v_permlane16_swap_b32 v225, v232
  v_max_f32 v225, v225, v232
  v_sub_f32 v212, 0, v225
  v_sub_f32 v213, 0, v225
  v_sub_f32 v214, 0, v225
  v_sub_f32 v215, 0, v225
  v_mov_b32 v232, v226
  s_nop 1
  v_permlane32_swap_b32 v226, v232
  v_max_f32 v226, v226, v232
  v_mov_b32 v232, v226
  s_nop 1
  v_permlane16_swap_b32 v226, v232
  v_max_f32 v226, v226, v232
  v_sub_f32 v216, 0, v226
  v_sub_f32 v217, 0, v226
  v_sub_f32 v218, 0, v226
  v_sub_f32 v219, 0, v226
  v_mov_b32 v232, v227
  s_nop 1
  v_permlane32_swap_b32 v227, v232
  v_max_f32 v227, v227, v232
  v_mov_b32 v232, v227
  s_nop 1
  v_permlane16_swap_b32 v227, v232
  v_max_f32 v227, v227, v232
  v_sub_f32 v220, 0, v227
  v_sub_f32 v221, 0, v227
  v_sub_f32 v222, 0, v227
  v_sub_f32 v223, 0, v227
  v_mfma_f32_32x32x16_bf16 a[0:15], v[228:231], v[228:231], 0
  v_mfma_f32_32x32x16_bf16 a[16:31], v[228:231], v[228:231], 0
  v_mfma_f32_32x32x16_bf16 a[32:47], v[228:231], v[228:231], 0
  v_mfma_f32_32x32x16_bf16 a[48:63], v[228:231], v[228:231], 0
  v_mfma_f32_32x32x16_bf16 a[64:79], v[228:231], v[228:231], 0
  v_mfma_f32_32x32x16_bf16 a[80:95], v[228:231], v[228:231], 0
  v_mfma_f32_32x32x16_bf16 a[96:111], v[228:231], v[228:231], 0
  v_mfma_f32_32x32x16_bf16 a[112:127], v[228:231], v[228:231], 0
  v_mfma_f32_32x32x16_bf16 a[128:143], v[228:231], v[228:231], 0
  s_mov_b32 s43, 0
B_slow_p2:
  s_lshl_b32 s36, s43, 13
  s_mov_b32 s37, s36
  s_add_u32 m0, s33, 0x4000
  s_nop 0
  buffer_load_dwordx4 v10, s[8:11], s36 offen lds
  buffer_load_dwordx4 v11, s[8:11], s36 offen offset:1024 lds
  buffer_load_dwordx4 v12, s[8:11], s36 offen offset:2048 lds
  buffer_load_dwordx4 v13, s[8:11], s36 offen offset:3072 lds
  s_add_u32 m0, s33, 0x5000
  s_nop 0
  buffer_load_dwordx4 v14, s[8:11], s36 offen lds
  buffer_load_dwordx4 v15, s[8:11], s36 offen offset:1024 lds
  buffer_load_dwordx4 v16, s[8:11], s36 offen offset:2048 lds
  buffer_load_dwordx4 v17, s[8:11], s36 offen offset:3072 lds
  s_add_u32 s36, s36, 0x2000
  s_and_b32 s36, s36, 0x1ffff
  s_add_u32 m0, s34, 0
  s_nop 0
  buffer_load_dwordx4 v18, s[12:15], s37 offen lds
  buffer_load_dwordx4 v19, s[12:15], s37 offen offset:1024 lds
  buffer_load_dwordx4 v18, s[12:15], s37 offen offset:2048 lds
  buffer_load_dwordx4 v19, s[12:15], s37 offen offset:3072 lds
  s_add_u32 m0, s34, 0x1000
  s_nop 0
  buffer_load_dwordx4 v20, s[12:15], s37 offen lds
  buffer_load_dwordx4 v21, s[12:15], s37 offen offset:1024 lds
  buffer_load_dwordx4 v20, s[12:15], s37 offen offset:2048 lds
  buffer_load_dwordx4 v21, s[12:15], s37 offen offset:3072 lds
  s_add_u32 s37, s37, 0x2000
  s_and_b32 s37, s37, 0x1ffff
  s_waitcnt vmcnt(0)
  ds_read_b128 a[164:167], v30 offset:16384
  s_waitcnt lgkmcnt(0)
  v_mfma_f32_16x16x32_bf16 v[128:131], a[164:167], v[64:67], v[208:211]
  v_mfma_f32_16x16x32_bf16 v[132:135], a[164:167], v[80:83], v[212:215]
  v_mfma_f32_16x16x32_bf16 v[136:139], a[164:167], v[96:99], v[216:219]
  v_mfma_f32_16x16x32_bf16 v[140:143], a[164:167], v[112:115], v[220:223]
  ds_read_b128 a[168:171], v31 offset:16384
  s_waitcnt lgkmcnt(0)
  v_mfma_f32_16x16x32_bf16 v[128:131], a[168:171], v[68:71], v[128:131]
  v_mfma_f32_16x16x32_bf16 v[132:135], a[168:171], v[84:87], v[132:135]
  v_mfma_f32_16x16x32_bf16 v[136:139], a[168:171], v[100:103], v[136:139]
  v_mfma_f32_16x16x32_bf16 v[140:143], a[168:171], v[116:119], v[140:143]
  ds_read_b128 a[172:175], v32 offset:16384
  s_waitcnt lgkmcnt(0)
  v_mfma_f32_16x16x32_bf16 v[128:131], a[172:175], v[72:75], v[128:131]
  v_mfma_f32_16x16x32_bf16 v[132:135], a[172:175], v[88:91], v[132:135]
  v_mfma_f32_16x16x32_bf16 v[136:139], a[172:175], v[104:107], v[136:139]
  v_mfma_f32_16x16x32_bf16 v[140:143], a[172:175], v[120:123], v[140:143]
  ds_read_b128 a[176:179], v33 offset:16384
  s_waitcnt lgkmcnt(0)
  v_mfma_f32_16x16x32_bf16 v[128:131], a[176:179], v[76:79], v[128:131]
  v_mfma_f32_16x16x32_bf16 v[132:135], a[176:179], v[92:95], v[132:135]
  v_mfma_f32_16x16x32_bf16 v[136:139], a[176:179], v[108:111], v[136:139]
  v_mfma_f32_16x16x32_bf16 v[140:143], a[176:179], v[124:127], v[140:143]
  ds_read_b128 a[164:167], v30 offset:20480
  s_waitcnt lgkmcnt(0)
  v_mfma_f32_16x16x32_bf16 v[144:147], a[164:167], v[64:67], v[208:211]
  v_mfma_f32_16x16x32_bf16 v[148:151], a[164:167], v[80:83], v[212:215]
  v_mfma_f32_16x16x32_bf16 v[152:155], a[164:167], v[96:99], v[216:219]
  v_mfma_f32_16x16x32_bf16 v[156:159], a[164:167], v[112:115], v[220:223]
  ds_read_b128 a[168:171], v31 offset:20480
  s_waitcnt lgkmcnt(0)
  v_mfma_f32_16x16x32_bf16 v[144:147], a[168:171], v[68:71], v[144:147]
  v_mfma_f32_16x16x32_bf16 v[148:151], a[168:171], v[84:87], v[148:151]
  v_mfma_f32_16x16x32_bf16 v[152:155], a[168:171], v[100:103], v[152:155]
  v_mfma_f32_16x16x32_bf16 v[156:159], a[168:171], v[116:119], v[156:159]
  ds_read_b128 a[172:175], v32 offset:20480
  s_waitcnt lgkmcnt(0)
  v_mfma_f32_16x16x32_bf16 v[144:147], a[172:175], v[72:75], v[144:147]
  v_mfma_f32_16x16x32_bf16 v[148:151], a[172:175], v[88:91], v[148:151]
  v_mfma_f32_16x16x32_bf16 v[152:155], a[172:175], v[104:107], v[152:155]
  v_mfma_f32_16x16x32_bf16 v[156:159], a[172:175], v[120:123], v[156:159]
  ds_read_b128 a[176:179], v33 offset:20480
  s_waitcnt lgkmcnt(0)
  v_mfma_f32_16x16x32_bf16 v[144:147], a[176:179], v[76:79], v[144:147]
  v_mfma_f32_16x16x32_bf16 v[148:151], a[176:179], v[92:95], v[148:151]
  v_mfma_f32_16x16x32_bf16 v[152:155], a[176:179], v[108:111], v[152:155]
  v_mfma_f32_16x16x32_bf16 v[156:159], a[176:179], v[124:127], v[156:159]
  v_exp_f32 v128, v128
  v_exp_f32 v129, v129
  v_exp_f32 v130, v130
  v_exp_f32 v131, v131
  s_nop 0
  v_exp_f32 v144, v144
  v_exp_f32 v145, v145
  v_exp_f32 v146, v146
  v_exp_f32 v147, v147
  v_exp_f32 v132, v132
  v_exp_f32 v133, v133
  v_exp_f32 v134, v134
  v_exp_f32 v135, v135
  v_exp_f32 v148, v148
  v_exp_f32 v149, v149
  v_exp_f32 v150, v150
  v_exp_f32 v151, v151
  v_exp_f32 v136, v136
  v_exp_f32 v137, v137
  v_exp_f32 v138, v138
  v_exp_f32 v139, v139
  v_exp_f32 v152, v152
  v_exp_f32 v153, v153
  v_exp_f32 v154, v154
  v_exp_f32 v155, v155
  v_exp_f32 v140, v140
  v_exp_f32 v141, v141
  v_exp_f32 v142, v142
  v_exp_f32 v143, v143
  v_exp_f32 v156, v156
  v_exp_f32 v157, v157
  v_exp_f32 v158, v158
  v_exp_f32 v159, v159
  v_cvt_pk_bf16_f32 v192, v128, v129
  v_cvt_pk_bf16_f32 v193, v130, v131
  v_cvt_pk_bf16_f32 v194, v144, v145
  v_cvt_pk_bf16_f32 v195, v146, v147
  v_cvt_pk_bf16_f32 v196, v132, v133
  v_cvt_pk_bf16_f32 v197, v134, v135
  v_cvt_pk_bf16_f32 v198, v148, v149
  v_cvt_pk_bf16_f32 v199, v150, v151
  v_cvt_pk_bf16_f32 v200, v136, v137
  v_cvt_pk_bf16_f32 v201, v138, v139
  v_cvt_pk_bf16_f32 v202, v152, v153
  v_cvt_pk_bf16_f32 v203, v154, v155
  v_cvt_pk_bf16_f32 v204, v140, v141
  v_cvt_pk_bf16_f32 v205, v142, v143
  v_cvt_pk_bf16_f32 v206, v156, v157
  v_cvt_pk_bf16_f32 v207, v158, v159
  v_mfma_f32_16x16x32_bf16 a[128:131], a[144:147], v[192:195], a[128:131]
  v_mfma_f32_16x16x32_bf16 a[132:135], a[144:147], v[196:199], a[132:135]
  v_mfma_f32_16x16x32_bf16 a[136:139], a[144:147], v[200:203], a[136:139]
  v_mfma_f32_16x16x32_bf16 a[140:143], a[144:147], v[204:207], a[140:143]
  ds_read_b64_tr_b16 a[148:149], v22
  ds_read_b64_tr_b16 a[150:151], v22 offset:4096
  s_waitcnt lgkmcnt(0)
  v_mfma_f32_16x16x32_bf16 a[0:3], a[148:151], v[192:195], a[0:3]
  v_mfma_f32_16x16x32_bf16 a[4:7], a[148:151], v[196:199], a[4:7]
  v_mfma_f32_16x16x32_bf16 a[8:11], a[148:151], v[200:203], a[8:11]
  v_mfma_f32_16x16x32_bf16 a[12:15], a[148:151], v[204:207], a[12:15]
  ds_read_b64_tr_b16 a[152:153], v23
  ds_read_b64_tr_b16 a[154:155], v23 offset:4096
  s_waitcnt lgkmcnt(0)
  v_mfma_f32_16x16x32_bf16 a[16:19], a[152:155], v[192:195], a[16:19]
  v_mfma_f32_16x16x32_bf16 a[20:23], a[152:155], v[196:199], a[20:23]
  v_mfma_f32_16x16x32_bf16 a[24:27], a[152:155], v[200:203], a[24:27]
  v_mfma_f32_16x16x32_bf16 a[28:31], a[152:155], v[204:207], a[28:31]
  ds_read_b64_tr_b16 a[156:157], v24
  ds_read_b64_tr_b16 a[158:159], v24 offset:4096
  s_waitcnt lgkmcnt(0)
  v_mfma_f32_16x16x32_bf16 a[32:35], a[156:159], v[192:195], a[32:35]
  v_mfma_f32_16x16x32_bf16 a[36:39], a[156:159], v[196:199], a[36:39]
  v_mfma_f32_16x16x32_bf16 a[40:43], a[156:159], v[200:203], a[40:43]
  v_mfma_f32_16x16x32_bf16 a[44:47], a[156:159], v[204:207], a[44:47]
  ds_read_b64_tr_b16 a[160:161], v25
  ds_read_b64_tr_b16 a[162:163], v25 offset:4096
  s_waitcnt lgkmcnt(0)
  v_mfma_f32_16x16x32_bf16 a[48:51], a[160:163], v[192:195], a[48:51]
  v_mfma_f32_16x16x32_bf16 a[52:55], a[160:163], v[196:199], a[52:55]
  v_mfma_f32_16x16x32_bf16 a[56:59], a[160:163], v[200:203], a[56:59]
  v_mfma_f32_16x16x32_bf16 a[60:63], a[160:163], v[204:207], a[60:63]
  ds_read_b64_tr_b16 a[148:149], v26
  ds_read_b64_tr_b16 a[150:151], v26 offset:4096
  s_waitcnt lgkmcnt(0)
  v_mfma_f32_16x16x32_bf16 a[64:67], a[148:151], v[192:195], a[64:67]
  v_mfma_f32_16x16x32_bf16 a[68:71], a[148:151], v[196:199], a[68:71]
  v_mfma_f32_16x16x32_bf16 a[72:75], a[148:151], v[200:203], a[72:75]
  v_mfma_f32_16x16x32_bf16 a[76:79], a[148:151], v[204:207], a[76:79]
  ds_read_b64_tr_b16 a[152:153], v27
  ds_read_b64_tr_b16 a[154:155], v27 offset:4096
  s_waitcnt lgkmcnt(0)
  v_mfma_f32_16x16x32_bf16 a[80:83], a[152:155], v[192:195], a[80:83]
  v_mfma_f32_16x16x32_bf16 a[84:87], a[152:155], v[196:199], a[84:87]
  v_mfma_f32_16x16x32_bf16 a[88:91], a[152:155], v[200:203], a[88:91]
  v_mfma_f32_16x16x32_bf16 a[92:95], a[152:155], v[204:207], a[92:95]
  ds_read_b64_tr_b16 a[156:157], v28
  ds_read_b64_tr_b16 a[158:159], v28 offset:4096
  s_waitcnt lgkmcnt(0)
  v_mfma_f32_16x16x32_bf16 a[96:99], a[156:159], v[192:195], a[96:99]
  v_mfma_f32_16x16x32_bf16 a[100:103], a[156:159], v[196:199], a[100:103]
  v_mfma_f32_16x16x32_bf16 a[104:107], a[156:159], v[200:203], a[104:107]
  v_mfma_f32_16x16x32_bf16 a[108:111], a[156:159], v[204:207], a[108:111]
  ds_read_b64_tr_b16 a[160:161], v29
  ds_read_b64_tr_b16 a[162:163], v29 offset:4096
  s_waitcnt lgkmcnt(0)
  v_mfma_f32_16x16x32_bf16 a[112:115], a[160:163], v[192:195], a[112:115]
  v_mfma_f32_16x16x32_bf16 a[116:119], a[160:163], v[196:199], a[116:119]
  v_mfma_f32_16x16x32_bf16 a[120:123], a[160:163], v[200:203], a[120:123]
  v_mfma_f32_16x16x32_bf16 a[124:127], a[160:163], v[204:207], a[124:127]
  s_waitcnt vmcnt(0) lgkmcnt(0)
  s_nop 15
  s_add_u32 s43, s43, 1
  s_cmp_lt_u32 s43, 16
  s_cbranch_scc1 B_slow_p2
  s_nop 15
  s_branch B_norm
B_end:
  s_endpgm
.section .rodata,"a"
.p2align 6
.amdhsa_kernel adaLN_cond__sliding_block_cached__glu_gated_bilinear__prompt_kernel
  .amdhsa_next_free_vgpr 512
  .amdhsa_next_free_sgpr 102
  .amdhsa_accum_offset 256
  .amdhsa_group_segment_fixed_size 0
  .amdhsa_kernarg_size 112
  .amdhsa_user_sgpr_count 2
  .amdhsa_user_sgpr_kernarg_segment_ptr 1
  .amdhsa_system_sgpr_workgroup_id_x 1
  .amdhsa_float_denorm_mode_32 3
.end_amdhsa_kernel
```
